```python
import torch

def _softmax(x, axis=-1):
    return torch.softmax(x, dim=axis)
def _gelu(x):
    return torch.nn.functional.gelu(x, approximate="tanh")
def _silu(x):
    return torch.nn.functional.silu(x)
def _sigmoid(x):
    return torch.sigmoid(x)
def _layernorm(x, axis=-1, eps=1e-5):
    m = x.mean(dim=axis, keepdim=True)
    v = x.var(dim=axis, keepdim=True, unbiased=False)
    return (x - m) / torch.sqrt(v + eps)
def _scatter_add(tgt, idx, src, axis=0):
    return tgt.clone().index_add_(axis, idx, src)
def _segment_sum(src, seg, n):
    out = torch.zeros((n,) + src.shape[1:], dtype=src.dtype)
    return out.index_add_(0, seg, src)
def _pad(x, pw):
    flat = tuple(v for pair in reversed(pw) for v in pair)
    return torch.nn.functional.pad(x, flat)

kernel_name = 'recurrent_scan__sliding_block_cached__geglu_ffn__decode'

def setup_inputs():

    _w = (lambda a: (lambda t: t.to(torch.bfloat16) if t.is_floating_point() else t)(torch.as_tensor(a)))
    def _A_setup():
        B, Sq, D = 1, 1, 512
        Hq, Hkv, Sk, Dh = 32, 8, 65536, 128
        assert Hq % Hkv == 0, (Hq, Hkv)
        return {
            "x": _w((lambda *s: torch.randn(*s, dtype=torch.bfloat16) * 0.05)(B, Sq, D)),
            "k_cache": _w((lambda *s: torch.randn(*s, dtype=torch.bfloat16) * 1.6)(B, Hkv, Sk, Dh)),
            "v_cache": _w((lambda *s: torch.randn(*s, dtype=torch.bfloat16) * 0.2)(B, Hkv, Sk, Dh)),
            "wq": _w((lambda *s: torch.randn(*s, dtype=torch.bfloat16) * 1.6)(D, Hq * Dh) * (D ** -0.5)),
            "wo": _w((lambda *s: torch.randn(*s, dtype=torch.bfloat16) * 0.2)(Hq * Dh, D) * ((Hq * Dh) ** -0.5)),
        }
    _A_in = _A_setup()

    def _B_setup():
        B, S, D, F = 1, 1, 512, 1792
        return {
            "x": _w((lambda *s: torch.randn(*s, dtype=torch.bfloat16) * 0.05)(B, S, D)),
            "w_gate": _w((lambda *s: torch.randn(*s, dtype=torch.bfloat16) * 0.1)(D, F)),
            "w_up": _w((lambda *s: torch.randn(*s, dtype=torch.bfloat16) * 0.1)(D, F)),
            "w_down": _w((lambda *s: torch.randn(*s, dtype=torch.bfloat16) * 0.1)(F, D)),
        }
    _B_in = _B_setup()

    return {
        "A_x": _A_in["x"],
        "A_k_cache": _A_in["k_cache"],
        "A_v_cache": _A_in["v_cache"],
        "A_wq": _A_in["wq"],
        "A_wo": _A_in["wo"],
        "B_x": _B_in["x"],
        "B_w_gate": _B_in["w_gate"],
        "B_w_up": _B_in["w_up"],
        "B_w_down": _B_in["w_down"],
    }

def reference(A_x, A_k_cache, A_v_cache, A_wq, A_wo, B_x, B_w_gate, B_w_up, B_w_down):
    def _A_ref(x, k_cache, v_cache, wq, wo):
        B, Sq, D = x.shape
        Hq, Dh = 32, 128
        Hkv, Sk = k_cache.shape[1], k_cache.shape[2]
        W = min(4096, max(256, Sk // 4))
        rep = Hq // Hkv
        q = (lambda x, *d: x.permute(*d))((x @ wq).reshape(B, Sq, Hq, Dh), 0, 2, 1, 3)
        k = (lambda x, n, axis: torch.repeat_interleave(x, n, dim=axis))(k_cache[:, :, Sk - W:, :], rep, axis=1)
        v = (lambda x, n, axis: torch.repeat_interleave(x, n, dim=axis))(v_cache[:, :, Sk - W:, :], rep, axis=1)
        scores = torch.einsum("bhqd,bhkd->bhqk", q, k) * (Dh ** -0.5)
        p = _softmax(scores, axis=-1)
        o = torch.einsum("bhqk,bhkd->bhqd", p, v)
        return (lambda x, *d: x.permute(*d))(o, 0, 2, 1, 3).reshape(B, Sq, Hq * Dh) @ wo

    def _B_ref(x, w_gate, w_up, w_down):
        return (_gelu(x @ w_gate) * (x @ w_up)) @ w_down

    x = A_x
    xn = _layernorm(x, axis=-1)
    s = _A_ref(xn, A_k_cache, A_v_cache, A_wq, A_wo)
    g = _silu(_B_ref(xn, B_w_gate, B_w_up, B_w_down))
    return x + s * g
```

```asm
; @launch grid=(256,1,1) block=(384,1,1) lds=137216
.amdgcn_target "amdgcn-amd-amdhsa--gfx950"
.text
.globl recurrent_scan__sliding_block_cached__geglu_ffn__decode_kernel
.p2align 12
.p2align 8
.type recurrent_scan__sliding_block_cached__geglu_ffn__decode_kernel,@function
recurrent_scan__sliding_block_cached__geglu_ffn__decode_kernel:
    s_load_dwordx16 s[4:19], s[0:1], 0
    s_load_dwordx8 s[20:27], s[0:1], 64
    v_lshrrev_b32 v4, 6, v0
    v_and_b32 v1, 63, v0
    v_readfirstlane_b32 s28, v4
    s_cmp_ge_u32 s2, 256
    s_cbranch_scc1 L_end
    s_and_b32 s29, s2, 7
    s_lshr_b32 s30, s2, 3
    s_lshr_b32 s31, s30, 3
    s_add_u32 s32, s30, 0
    s_and_b32 s32, s32, 7
    v_lshrrev_b32 v3, 4, v1
    s_cmp_lg_u32 s28, 0
    s_cbranch_scc1 L_xload
    v_lshrrev_b32 v2, 3, v1
    v_and_b32 v5, 7, v1
    v_lshlrev_b32 v6, 1, v3
    v_xor_b32 v5, v6, v5
    v_lshlrev_b32 v5, 4, v5
    v_lshl_add_u32 v20, v2, 13, v5
    v_mov_b32 v21, v20
    s_lshl_b32 s46, s31, 20
    s_lshl_b32 s34, s29, 10
    s_add_u32 s46, s46, s34
    s_lshl_b32 s35, s32, 7
    s_add_u32 s46, s46, s35
    s_mov_b32 s50, 4194304
    s_mov_b32 s51, 0x20000
    s_mov_b32 s52, 64512
    s_mov_b32 s53, 68608
    s_movk_i32 s55, 0x1000
    s_mov_b32 s43, -1
    s_mov_b32 m0, 0
    s_mov_b32 s54, 3
    s_getpc_b64 s[62:63]
L_pc0:
    s_add_u32 s62, s62, L_ld_start - L_pc0
    s_addc_u32 s63, s63, 0
    s_waitcnt lgkmcnt(0)
    s_mov_b32 s48, s10
    s_mov_b32 s49, s11
L_quads:
    buffer_load_dwordx4 v20, s[48:51], s46 offen nt lds
    s_add_u32 s46, s46, s52
    buffer_load_dwordx4 v21, s[48:51], s46 offen offset:1024 nt lds
    s_add_u32 s46, s46, s52
    buffer_load_dwordx4 v20, s[48:51], s46 offen offset:2048 nt lds
    s_add_u32 s46, s46, s52
    buffer_load_dwordx4 v21, s[48:51], s46 offen offset:3072 nt lds
    s_add_u32 s46, s46, s53
    s_add_u32 m0, m0, s55
    s_cmp_ge_u32 s46, s43
    s_cselect_b32 s34, s44, 0
    s_cselect_b32 s47, s45, 0
    s_sub_u32 s46, s46, s34
    s_sub_u32 m0, m0, s47
    s_sub_u32 s54, s54, 1
    s_cbranch_scc0 L_quads
    s_setpc_b64 s[62:63]
L_xload:
    v_lshlrev_b32 v4, 4, v1
    s_and_b32 s33, s30, 3
    s_getpc_b64 s[34:35]
L_pc1:
    s_mul_i32 s33, s33, 5120
    v_lshlrev_b32 v15, 4, v0
    v_add_u32 v15, s33, v15
    v_cmp_gt_u32 vcc, L_end - L_pc1 + 1024 - 12, v15
    s_nop 0
    s_and_saveexec_b64 s[36:37], vcc
    s_cbranch_execz L_nopf0
    global_load_dwordx4 v[160:163], v15, s[34:35] offset:-1024
L_nopf0:
    s_mov_b64 exec, -1
    s_setprio 2
    s_mov_b32 s42, 1024
    s_mov_b32 s43, 0x20000
    s_waitcnt lgkmcnt(0)
    s_mov_b32 s40, s4
    s_mov_b32 s41, s5
    buffer_load_dwordx4 v[20:23], v4, s[40:43], 0 offen
    s_load_dword s44, s[26:27], 0
    s_branch L_compute
L_ld3b:
    s_barrier
    s_branch L_ld3
L_ld_start:
    v_mov_b32 v14, 57344
    s_lshl_b32 s33, s29, 2
    s_add_u32 s33, s33, s31
    v_mul_u32_u24 v7, 3584, v2
    v_add_u32 v7, v7, v5
    v_lshl_add_u32 v8, v2, 10, v5
    v_and_b32 v2, 15, v1
    v_xor_b32 v9, v6, v2
    v_lshlrev_b32 v9, 4, v9
    v_lshl_add_u32 v9, v3, 8, v9
    v_xor_b32 v10, 0x80, v9
    s_lshl_b32 s58, s29, 24
    s_lshl_b32 s34, s30, 10
    s_add_u32 s58, s58, s34
    s_add_u32 s58, s58, 15728640
    s_lshl_b32 s59, s33, 17
    s_add_u32 s59, s59, s35
    s_mul_i32 s40, s33, 7
    s_add_u32 s40, s40, s32
    s_cmp_gt_u32 s32, 3
    s_subb_u32 s40, s40, 0
    s_and_b32 s41, s40, 7
    s_lshr_b32 s40, s40, 3
    s_cmp_eq_u32 s32, 3
    s_cbranch_scc1 L_ld3b
    s_mul_i32 s57, s41, 229376
    s_lshl_b32 s34, s40, 7
    s_add_u32 s57, s57, s34
    s_lshl_b32 s60, s40, 16
    s_lshl_b32 s34, s41, 7
    s_add_u32 s60, s60, s34
    s_setprio 3
    s_mov_b32 s48, s16
    s_mov_b32 s49, s17
    s_mov_b32 s50, 1835008
    s_mov_b32 s46, s57
    s_mov_b32 s43, -1
    s_mov_b32 m0, 16384
    v_mov_b32 v20, v7
    v_mov_b32 v21, v7
    s_mov_b32 s52, 27648
    s_mov_b32 s53, 31744
    s_mov_b32 s54, 1
    s_call_b64 s[62:63], L_quads
    s_mov_b32 s48, s18
    s_mov_b32 s49, s19
    s_mov_b32 s50, 1835008
    s_mov_b32 s46, s57
    s_mov_b32 s43, -1
    s_mov_b32 m0, 24576
    s_mov_b32 s54, 1
    s_call_b64 s[62:63], L_quads
    s_barrier
    s_mov_b32 s48, s6
    s_mov_b32 s49, s7
    s_mov_b32 s50, 134217728
    s_mul_i32 s34, s29, 1
    s_add_u32 s34, s34, 0
    s_and_b32 s34, s34, 7
    s_mul_i32 s46, s34, 131072
    s_add_u32 s46, s46, s58
    s_add_u32 s43, s58, 1048576
    s_mov_b32 s44, 1048576
    s_mov_b32 s45, 0
    s_mov_b32 m0, 65536
    v_mov_b32 v20, v9
    v_mov_b32 v21, v10
    s_mov_b32 s52, 31744
    s_mov_b32 s53, 35840
    s_mov_b32 s54, 2
    s_call_b64 s[62:63], L_quads
    s_waitcnt vmcnt(28)
    v_mov_b32 v12, 1
    s_mov_b64 exec, 1
    ds_write_b32 v14, v12
    s_mov_b64 exec, -1
L_ahq:
    ds_read_b128 v[16:19], v14 offset:64
    s_waitcnt lgkmcnt(0)
    v_and_b32 v16, v16, v17
    v_and_b32 v18, v18, v19
    v_and_b32 v16, v16, v18
    s_nop 0
    v_readfirstlane_b32 s34, v16
    s_nop 0
    s_cmp_eq_u32 s34, 0
    s_cbranch_scc1 L_ahq
    s_mov_b32 s54, 1
    s_call_b64 s[62:63], L_quads
    s_mov_b32 s54, 0
    s_call_b64 s[62:63], L_quads
    s_waitcnt vmcnt(24)
    v_mov_b32 v12, 2
    s_mov_b64 exec, 1
    ds_write_b32 v14, v12
    s_mov_b64 exec, -1
    s_mov_b32 s54, 0
    s_call_b64 s[62:63], L_quads
    s_waitcnt vmcnt(20)
    s_mov_b32 s54, 0
    s_call_b64 s[62:63], L_quads
    s_waitcnt vmcnt(20)
    s_mov_b32 s48, s20
    s_mov_b32 s49, s21
    s_mov_b32 s50, 1835008
    s_mov_b32 s46, s60
    s_mov_b32 s43, -1
    s_mov_b32 m0, 49152
    v_mov_b32 v20, v8
    v_mov_b32 v21, v8
    s_mov_b32 s52, 7168
    s_mov_b32 s53, 11264
    s_mov_b32 s54, 0
    s_call_b64 s[62:63], L_quads
    s_waitcnt vmcnt(20)
    s_mov_b32 s54, 0
    s_call_b64 s[62:63], L_quads
    s_waitcnt vmcnt(20)
    v_mov_b32 v12, 3
    s_mov_b64 exec, 1
    ds_write_b32 v14, v12
    s_mov_b64 exec, -1
L_ahg:
    ds_read_b128 v[16:19], v14 offset:96
    s_waitcnt lgkmcnt(0)
    v_and_b32 v16, v16, v17
    v_and_b32 v18, v18, v19
    v_and_b32 v16, v16, v18
    s_nop 0
    v_readfirstlane_b32 s34, v16
    s_nop 0
    s_cmp_eq_u32 s34, 0
    s_cbranch_scc1 L_ahg
    s_mov_b32 s48, s12
    s_mov_b32 s49, s13
    s_mov_b32 s50, 4194304
    s_mov_b32 s46, s59
    s_mov_b32 s43, -1
    s_mov_b32 m0, 32768
    s_mov_b32 s54, 3
    s_call_b64 s[62:63], L_quads
    s_mov_b32 s48, s8
    s_mov_b32 s49, s9
    s_mov_b32 s50, 134217728
    s_mul_i32 s34, s29, 1
    s_add_u32 s34, s34, 0
    s_and_b32 s34, s34, 7
    s_mul_i32 s46, s34, 131072
    s_add_u32 s46, s46, s58
    s_add_u32 s43, s58, 1048576
    s_mov_b32 s44, 1048576
    s_mov_b32 s45, 0
    s_mov_b32 m0, 98304
    v_mov_b32 v20, v9
    v_mov_b32 v21, v10
    s_mov_b32 s52, 31744
    s_mov_b32 s53, 35840
    s_mov_b32 s54, 1
    s_call_b64 s[62:63], L_quads
    s_waitcnt vmcnt(32)
    v_mov_b32 v12, 4
    s_mov_b64 exec, 1
    ds_write_b32 v14, v12
    s_mov_b64 exec, -1
    s_mov_b32 s54, 1
    s_call_b64 s[62:63], L_quads
    s_waitcnt vmcnt(32)
    v_mov_b32 v12, 5
    s_mov_b64 exec, 1
    ds_write_b32 v14, v12
    s_mov_b64 exec, -1
    s_mov_b32 s54, 3
    s_call_b64 s[62:63], L_quads
    s_waitcnt vmcnt(32)
    v_mov_b32 v12, 6
    s_mov_b64 exec, 1
    ds_write_b32 v14, v12
    s_mov_b64 exec, -1
    s_setprio 3
    s_mov_b64 exec, 1
    v_mov_b32 v31, 7
    s_waitcnt vmcnt(24)
    ds_write_b32 v14, v31
    v_mov_b32 v32, 8
    s_waitcnt vmcnt(16)
    ds_write_b32 v14, v32
    v_mov_b32 v33, 9
    s_waitcnt vmcnt(8)
    ds_write_b32 v14, v33
    v_mov_b32 v34, 10
    s_waitcnt vmcnt(0)
    ds_write_b32 v14, v34
    s_endpgm
L_compute:
    s_mov_b32 s38, 1048576
    s_mov_b32 s39, 0x20000
    v_and_b32 v2, 15, v1
    v_mov_b32 v14, 57344
    s_lshl_b32 s33, s29, 2
    s_add_u32 s33, s33, s31
    s_sub_u32 s28, s28, 1
    s_mov_b32 s36, s26
    s_mov_b32 s37, s27
    s_lshl_b32 s34, s28, 2
    v_add_u32 v5, s34, v14
    v_mov_b32 v6, 1
    s_lshl_b32 s46, s28, 10
    s_add_u32 s46, s46, 59392
    v_add_u32 v7, s46, v4
    s_mov_b32 s63, 0
    v_lshrrev_b32 v8, 2, v2
    v_lshl_add_u32 v8, v3, 2, v8
    v_lshrrev_b32 v15, 1, v8
    v_and_b32 v15, 3, v15
    v_and_b32 v16, 3, v2
    v_lshlrev_b32 v16, 3, v16
    v_lshl_add_u32 v17, v8, 7, v16
    v_lshl_add_u32 v10, v15, 5, v17
    v_xor_b32 v11, 32, v10
    v_xor_b32 v12, 64, v10
    v_xor_b32 v13, 96, v10
    s_mov_b32 s47, 4294966272
    s_mov_b32 s54, 0x00010001
    s_mov_b32 s55, 0x00010001
    s_cmp_lg_u32 s28, 1
    s_cbranch_scc1 L_noinit
    v_mov_b32 v15, 0
    v_lshl_add_u32 v17, v1, 2, v14
    ds_write_b32 v17, v15
    s_waitcnt lgkmcnt(0)
L_noinit:
    s_barrier
    s_cmp_eq_u32 s28, 4
    s_cbranch_scc1 L_ffn
    v_lshlrev_b32 v152, 4, v3
    s_lshl_b32 s34, s28, 5
    v_xor_b32 v153, s34, v10
    s_lshl_b32 s34, s31, 8
    s_add_u32 s34, s34, s46
    v_lshl_add_u32 v156, v3, 3, s34
    s_lshl_b32 s48, s33, 11
    s_lshl_b32 s34, s32, 8
    s_add_u32 s48, s48, s34
    s_lshl_b32 s34, s28, 6
    s_add_u32 s48, s48, s34
    s_add_u32 s48, s48, 65536
    s_lshl_b32 s50, s29, 9
    s_add_u32 s50, s50, 8192
    s_lshl_b32 s34, s30, 4
    s_add_u32 s51, s50, s34
    s_getreg_b32 s61, hwreg(HW_REG_XCC_ID, 0, 4)
    s_lshl_b32 s60, s61, 16
    s_waitcnt vmcnt(0)
    v_lshlrev_b32 v24, 16, v20
    v_and_b32 v25, 0xffff0000, v20
    v_lshlrev_b32 v26, 16, v21
    v_and_b32 v27, 0xffff0000, v21
    v_lshlrev_b32 v28, 16, v22
    v_and_b32 v29, 0xffff0000, v22
    v_lshlrev_b32 v30, 16, v23
    v_and_b32 v31, 0xffff0000, v23
    v_pk_add_f32 v[32:33], v[24:25], v[26:27]
    v_pk_add_f32 v[34:35], v[28:29], v[30:31]
    v_pk_add_f32 v[32:33], v[32:33], v[34:35]
    v_add_f32 v32, v32, v33
    s_nop 1
    v_add_f32_dpp v32, v32, v32 row_ror:8 row_mask:0xf bank_mask:0xf
    s_nop 1
    v_add_f32_dpp v32, v32, v32 row_ror:4 row_mask:0xf bank_mask:0xf
    s_nop 1
    v_add_f32_dpp v32, v32, v32 row_ror:2 row_mask:0xf bank_mask:0xf
    s_nop 1
    v_add_f32_dpp v32, v32, v32 row_ror:1 row_mask:0xf bank_mask:0xf
    v_mov_b32 v33, v32
    s_nop 1
    v_permlane16_swap_b32 v33, v32
    v_add_f32 v32, v32, v33
    v_mov_b32 v33, v32
    s_nop 1
    v_permlane32_swap_b32 v33, v32
    v_add_f32 v32, v32, v33
    v_mul_f32 v32, 0x3b000000, v32
    v_pk_add_f32 v[36:37], v[24:25], v[32:33] op_sel_hi:[1,0] neg_lo:[0,1] neg_hi:[0,1]
    v_pk_add_f32 v[38:39], v[26:27], v[32:33] op_sel_hi:[1,0] neg_lo:[0,1] neg_hi:[0,1]
    v_pk_add_f32 v[40:41], v[28:29], v[32:33] op_sel_hi:[1,0] neg_lo:[0,1] neg_hi:[0,1]
    v_pk_add_f32 v[42:43], v[30:31], v[32:33] op_sel_hi:[1,0] neg_lo:[0,1] neg_hi:[0,1]
    v_pk_mul_f32 v[34:35], v[36:37], v[36:37]
    v_pk_fma_f32 v[34:35], v[38:39], v[38:39], v[34:35]
    v_pk_fma_f32 v[34:35], v[40:41], v[40:41], v[34:35]
    v_pk_fma_f32 v[34:35], v[42:43], v[42:43], v[34:35]
    v_add_f32 v33, v34, v35
    s_nop 1
    v_add_f32_dpp v33, v33, v33 row_ror:8 row_mask:0xf bank_mask:0xf
    s_nop 1
    v_add_f32_dpp v33, v33, v33 row_ror:4 row_mask:0xf bank_mask:0xf
    s_nop 1
    v_add_f32_dpp v33, v33, v33 row_ror:2 row_mask:0xf bank_mask:0xf
    s_nop 1
    v_add_f32_dpp v33, v33, v33 row_ror:1 row_mask:0xf bank_mask:0xf
    v_mov_b32 v34, v33
    s_nop 1
    v_permlane16_swap_b32 v34, v33
    v_add_f32 v33, v33, v34
    v_mov_b32 v34, v33
    s_nop 1
    v_permlane32_swap_b32 v34, v33
    v_add_f32 v33, v33, v34
    v_mul_f32 v33, 0x3b000000, v33
    v_cvt_pk_bf16_f32 v33, v32, v33
    v_lshlrev_b32 v32, 16, v33
    v_and_b32 v33, 0xffff0000, v33
    v_add_f32 v34, 0x3727c5ac, v33
    v_pk_add_f32 v[24:25], v[24:25], v[32:33] op_sel_hi:[1,0] neg_lo:[0,1] neg_hi:[0,1]
    v_pk_add_f32 v[26:27], v[26:27], v[32:33] op_sel_hi:[1,0] neg_lo:[0,1] neg_hi:[0,1]
    v_cvt_pk_bf16_f32 v34, v34, v34
    v_lshlrev_b32 v34, 16, v34
    v_sqrt_f32 v34, v34
    v_pk_add_f32 v[28:29], v[28:29], v[32:33] op_sel_hi:[1,0] neg_lo:[0,1] neg_hi:[0,1]
    v_pk_add_f32 v[30:31], v[30:31], v[32:33] op_sel_hi:[1,0] neg_lo:[0,1] neg_hi:[0,1]
    v_cvt_pk_bf16_f32 v34, v34, v34
    v_lshlrev_b32 v34, 16, v34
    v_rcp_f32 v44, v34
    v_cvt_pk_bf16_f32 v25, v24, v25
    v_lshlrev_b32 v24, 16, v25
    v_and_b32 v25, 0xffff0000, v25
    v_cvt_pk_bf16_f32 v27, v26, v27
    v_lshlrev_b32 v26, 16, v27
    v_and_b32 v27, 0xffff0000, v27
    v_cvt_pk_bf16_f32 v29, v28, v29
    v_lshlrev_b32 v28, 16, v29
    v_and_b32 v29, 0xffff0000, v29
    v_cvt_pk_bf16_f32 v31, v30, v31
    v_lshlrev_b32 v30, 16, v31
    v_and_b32 v31, 0xffff0000, v31
    v_pk_mul_f32 v[36:37], v[24:25], v[44:45] op_sel_hi:[1,0]
    v_pk_mul_f32 v[38:39], v[26:27], v[44:45] op_sel_hi:[1,0]
    v_pk_mul_f32 v[40:41], v[28:29], v[44:45] op_sel_hi:[1,0]
    v_pk_mul_f32 v[42:43], v[30:31], v[44:45] op_sel_hi:[1,0]
    v_pk_fma_f32 v[24:25], v[36:37], v[34:35], v[24:25] op_sel_hi:[1,0,1] neg_lo:[1,0,0] neg_hi:[1,0,0]
    v_pk_fma_f32 v[26:27], v[38:39], v[34:35], v[26:27] op_sel_hi:[1,0,1] neg_lo:[1,0,0] neg_hi:[1,0,0]
    v_pk_fma_f32 v[28:29], v[40:41], v[34:35], v[28:29] op_sel_hi:[1,0,1] neg_lo:[1,0,0] neg_hi:[1,0,0]
    v_pk_fma_f32 v[30:31], v[42:43], v[34:35], v[30:31] op_sel_hi:[1,0,1] neg_lo:[1,0,0] neg_hi:[1,0,0]
    v_pk_fma_f32 v[36:37], v[24:25], v[44:45], v[36:37] op_sel_hi:[1,0,1]
    v_pk_fma_f32 v[38:39], v[26:27], v[44:45], v[38:39] op_sel_hi:[1,0,1]
    v_pk_fma_f32 v[40:41], v[28:29], v[44:45], v[40:41] op_sel_hi:[1,0,1]
    v_pk_fma_f32 v[42:43], v[30:31], v[44:45], v[42:43] op_sel_hi:[1,0,1]
    v_cvt_pk_bf16_f32 v24, v36, v37
    v_cvt_pk_bf16_f32 v25, v38, v39
    v_cvt_pk_bf16_f32 v26, v40, v41
    v_cvt_pk_bf16_f32 v27, v42, v43
    ds_write_b128 v7, v[24:27]
    ds_read2_b64 v[24:27], v156 offset0:0 offset1:4
    ds_read2_b64 v[28:31], v156 offset0:8 offset1:12
    ds_read2_b64 v[32:35], v156 offset0:16 offset1:20
    ds_read2_b64 v[36:39], v156 offset0:24 offset1:28
    s_waitcnt lgkmcnt(0)
    s_add_u32 s44, s44, 1
    s_and_b32 s45, s44, 1023
    v_mov_b32 v9, s45
    v_or_b32 v44, s60, v9
    v_mov_b32 v45, v9
    v_mov_b32 v46, v9
    v_mov_b32 v47, v9
    s_cmp_ge_u32 s63, 1
    s_cbranch_scc1 L_wq_ok
L_wq:
    ds_read_b32 v15, v14
    s_waitcnt lgkmcnt(0)
    v_readfirstlane_b32 s63, v15
    s_nop 0
    s_cmp_ge_u32 s63, 1
    s_cbranch_scc0 L_wq
L_wq_ok:
    ds_read_b64_tr_b16 v[56:57], v153 offset:0
    ds_read_b64_tr_b16 v[58:59], v153 offset:2048
    ds_read_b64_tr_b16 v[60:61], v153 offset:4096
    ds_read_b64_tr_b16 v[62:63], v153 offset:6144
    ds_read_b64_tr_b16 v[64:65], v153 offset:8192
    ds_read_b64_tr_b16 v[66:67], v153 offset:10240
    ds_read_b64_tr_b16 v[68:69], v153 offset:12288
    ds_read_b64_tr_b16 v[70:71], v153 offset:14336
    s_waitcnt lgkmcnt(6)
    v_mfma_f32_16x16x32_bf16 v[40:43], v[56:59], v[24:27], 0
    s_waitcnt lgkmcnt(4)
    v_mfma_f32_16x16x32_bf16 v[40:43], v[60:63], v[28:31], v[40:43]
    s_waitcnt lgkmcnt(2)
    v_mfma_f32_16x16x32_bf16 v[40:43], v[64:67], v[32:35], v[40:43]
    s_waitcnt lgkmcnt(0)
    v_mfma_f32_16x16x32_bf16 v[40:43], v[68:71], v[36:39], v[40:43]
    s_mov_b64 exec, s[54:55]
    s_nop 6
    v_add_u32 v40, 512, v40
    v_add_u32 v41, 512, v41
    v_add_u32 v42, 512, v42
    v_add_u32 v43, 512, v43
    v_and_or_b32 v40, v40, s47, v9
    v_and_or_b32 v41, v41, s47, v9
    v_and_or_b32 v42, v42, s47, v9
    v_and_or_b32 v43, v43, s47, v9
    buffer_store_dwordx4 v[40:43], v152, s[36:39], s48 offen sc1
    s_mov_b64 exec, 1
    s_cmp_lg_u32 s28, 0
    s_cbranch_scc1 L_noxc
    buffer_store_dwordx4 v[44:47], off, s[36:39], s51 sc1
L_noxc:
    ds_write_b32 v5, v6 offset:64
    s_mov_b64 exec, -1
    s_branch L_over3
L_ld3:
    s_setprio 3
    s_mov_b32 s48, s6
    s_mov_b32 s49, s7
    s_mov_b32 s50, 134217728
    s_mul_i32 s34, s29, 1
    s_add_u32 s34, s34, 0
    s_and_b32 s34, s34, 7
    s_mul_i32 s46, s34, 131072
    s_add_u32 s46, s46, s58
    s_add_u32 s43, s58, 1048576
    s_mov_b32 s44, 1048576
    s_mov_b32 s45, 0
    s_mov_b32 m0, 65536
    v_mov_b32 v20, v9
    v_mov_b32 v21, v10
    s_mov_b32 s52, 31744
    s_mov_b32 s53, 35840
    s_mov_b32 s54, 4
    s_call_b64 s[62:63], L_quads
    s_waitcnt vmcnt(20)
    v_mov_b32 v12, 1
    s_mov_b64 exec, 1
    ds_write_b32 v14, v12
    s_mov_b64 exec, -1
L_bhq:
    ds_read_b128 v[16:19], v14 offset:64
    s_waitcnt lgkmcnt(0)
    v_and_b32 v16, v16, v17
    v_and_b32 v18, v18, v19
    v_and_b32 v16, v16, v18
    s_nop 0
    v_readfirstlane_b32 s34, v16
    s_nop 0
    s_cmp_eq_u32 s34, 0
    s_cbranch_scc1 L_bhq
    s_mov_b32 s54, 0
    s_call_b64 s[62:63], L_quads
    s_mov_b32 s54, 0
    s_call_b64 s[62:63], L_quads
    s_waitcnt vmcnt(20)
    s_mov_b32 s54, 0
    s_call_b64 s[62:63], L_quads
    s_waitcnt vmcnt(20)
    s_mov_b32 s48, s12
    s_mov_b32 s49, s13
    s_mov_b32 s50, 4194304
    s_mov_b32 s46, s59
    s_mov_b32 s43, -1
    s_mov_b32 m0, 32768
    v_mov_b32 v20, v8
    v_mov_b32 v21, v8
    s_mov_b32 s52, 7168
    s_mov_b32 s53, 11264
    s_mov_b32 s54, 0
    s_call_b64 s[62:63], L_quads
    s_waitcnt vmcnt(20)
    s_mov_b32 s54, 0
    s_call_b64 s[62:63], L_quads
    s_waitcnt vmcnt(20)
    s_mov_b32 s54, 0
    s_call_b64 s[62:63], L_quads
    s_waitcnt vmcnt(20)
    v_mov_b32 v12, 3
    s_mov_b64 exec, 1
    ds_write_b32 v14, v12
    s_mov_b64 exec, -1
L_bhg:
    ds_read_b128 v[16:19], v14 offset:96
    s_waitcnt lgkmcnt(0)
    v_and_b32 v16, v16, v17
    v_and_b32 v18, v18, v19
    v_and_b32 v16, v16, v18
    s_nop 0
    v_readfirstlane_b32 s34, v16
    s_nop 0
    s_cmp_eq_u32 s34, 0
    s_cbranch_scc1 L_bhg
    s_mov_b32 s54, 0
    s_call_b64 s[62:63], L_quads
    s_mov_b32 s48, s8
    s_mov_b32 s49, s9
    s_mov_b32 s50, 134217728
    s_mul_i32 s34, s29, 1
    s_add_u32 s34, s34, 0
    s_and_b32 s34, s34, 7
    s_mul_i32 s46, s34, 131072
    s_add_u32 s46, s46, s58
    s_add_u32 s43, s58, 1048576
    s_mov_b32 s44, 1048576
    s_mov_b32 s45, 0
    s_mov_b32 m0, 98304
    v_mov_b32 v20, v9
    v_mov_b32 v21, v10
    s_mov_b32 s52, 31744
    s_mov_b32 s53, 35840
    s_mov_b32 s54, 3
    s_call_b64 s[62:63], L_quads
    s_waitcnt vmcnt(32)
    v_mov_b32 v12, 4
    s_mov_b64 exec, 1
    ds_write_b32 v14, v12
    s_mov_b64 exec, -1
    s_mov_b32 s54, 3
    s_call_b64 s[62:63], L_quads
    s_waitcnt vmcnt(32)
    v_mov_b32 v12, 6
    s_mov_b64 exec, 1
    ds_write_b32 v14, v12
    s_mov_b64 exec, -1
    s_setprio 3
    s_mov_b64 exec, 1
    v_mov_b32 v31, 7
    s_waitcnt vmcnt(24)
    ds_write_b32 v14, v31
    v_mov_b32 v32, 8
    s_waitcnt vmcnt(16)
    ds_write_b32 v14, v32
    v_mov_b32 v33, 9
    s_waitcnt vmcnt(8)
    ds_write_b32 v14, v33
    v_mov_b32 v34, 10
    s_waitcnt vmcnt(0)
    ds_write_b32 v14, v34
    s_endpgm
L_over3:
    v_lshlrev_b32 v15, 4, v2
    v_lshl_add_u32 v136, v3, 11, v15
    s_mul_i32 s34, s28, 320
    s_add_u32 s34, s34, 57856
    v_and_b32 v15, 1, v3
    v_lshlrev_b32 v17, 7, v15
    v_lshl_add_u32 v17, v2, 3, v17
    v_lshrrev_b32 v18, 1, v3
    v_lshl_add_u32 v17, v18, 2, v17
    v_add_u32 v137, s34, v17
    v_and_b32 v17, 3, v1
    v_lshlrev_b32 v17, 4, v17
    v_lshl_add_u32 v17, v15, 1, v17
    v_bfe_u32 v15, v1, 2, 1
    v_lshl_add_u32 v17, v15, 3, v17
    v_bfe_u32 v15, v1, 3, 1
    v_lshl_add_u32 v17, v15, 2, v17
    s_lshl_b32 s34, s28, 6
    s_add_u32 s34, s34, 57600
    v_add_u32 v151, s34, v17
    v_and_b32 v17, 7, v1
    v_lshlrev_b32 v15, 1, v17
    v_xor_b32 v15, v15, v3
    v_lshlrev_b32 v15, 4, v15
    v_lshl_add_u32 v15, v2, 8, v15
    s_lshl_b32 s34, s28, 13
    s_add_u32 s34, s34, 65536
    v_add_u32 v138, s34, v15
    v_xor_b32 v139, 64, v138
    v_xor_b32 v140, 128, v138
    v_xor_b32 v141, 192, v138
    v_lshrrev_b32 v15, 3, v1
    v_lshlrev_b32 v17, 4, v17
    v_lshl_add_u32 v149, v15, 9, v17
    v_and_b32 v18, 3, v2
    v_mul_u32_u24 v142, 320, v18
    v_add_u32 v142, v142, v152
    s_lshl_b32 s34, s28, 10
    s_add_u32 s34, s34, 131072
    v_add_u32 v143, s34, v4
    v_add_u32 v155, 131072, v4
    v_lshlrev_b32 v15, 3, v1
    v_add_u32 v145, 135168, v15
    s_lshl_b32 s34, s28, 9
    v_add_u32 v144, s34, v145
    v_and_b32 v15, 7, v8
    s_lshl_b32 s34, s28, 1
    v_xor_b32 v15, s34, v15
    v_lshlrev_b32 v15, 5, v15
    v_lshl_add_u32 v15, v8, 8, v15
    v_add_u32 v15, v15, v16
    v_add_u32 v146, 98304, v15
    v_xor_b32 v147, 32, v146
    v_lshlrev_b32 v15, 14, v18
    v_lshrrev_b32 v17, 2, v2
    v_lshl_add_u32 v15, v17, 6, v15
    v_add_u32 v148, v15, v152
    v_and_b32 v154, 31, v1
    v_lshlrev_b32 v154, 4, v154
    s_lshl_b32 s49, s29, 13
    s_lshl_b32 s34, s28, 9
    s_add_u32 s49, s49, s34
    s_add_u32 s49, s49, 65536
    s_lshl_b32 s53, s29, 16
    s_lshl_b32 s34, s30, 9
    s_add_u32 s53, s53, s34
    s_lshl_b32 s35, s28, 7
    s_add_u32 s53, s53, s35
    s_add_u32 s53, s53, 524288
    s_lshl_b32 s56, s33, 14
    s_add_u32 s56, s56, s35
    s_add_u32 s56, s56, 524288
    s_add_u32 s57, s56, 4096
    s_add_u32 s4, s56, 8192
    s_add_u32 s5, s56, 12288
    s_lshl_b32 s59, s32, 13
    s_lshl_b32 s34, s33, 6
    s_add_u32 s59, s59, s34
    s_lshl_b32 s34, s28, 11
    s_add_u32 s59, s59, s34
    v_lshl_add_u32 v157, v2, 6, v152
    s_add_u32 s59, s59, 327680
    s_mov_b32 s46, 1069066811
    s_mov_b32 s10, 1035273459
    s_mov_b32 s11, 1035273459
    s_mov_b32 s16, 0x000f000f
    s_mov_b32 s17, 0x000f000f
    s_mov_b32 s18, 0x00f000f0
    s_mov_b32 s19, 0x00f000f0
    s_mov_b32 s14, 0x00ff00ff
    s_mov_b32 s15, 0x00ff00ff
    v_mov_b32 v104, 0
    v_mov_b32 v105, 0
    v_mov_b32 v106, 0
    v_mov_b32 v107, 0
    v_mov_b32 v108, 0
    v_mov_b32 v109, 0
    v_mov_b32 v110, 0
    v_mov_b32 v111, 0
    v_mov_b32 v112, 0
    v_mov_b32 v113, 0
    v_mov_b32 v114, 0
    v_mov_b32 v115, 0
    v_mov_b32 v116, 0
    v_mov_b32 v117, 0
    v_mov_b32 v118, 0
    v_mov_b32 v119, 0
    v_mov_b32 v120, 0
    v_mov_b32 v121, 0
    v_mov_b32 v122, 0
    v_mov_b32 v123, 0
    v_mov_b32 v124, 0
    v_mov_b32 v125, 0
    v_mov_b32 v126, 0
    v_mov_b32 v127, 0
    v_mov_b32 v128, 0
    v_mov_b32 v129, 0
    v_mov_b32 v130, 0
    v_mov_b32 v131, 0
    v_mov_b32 v132, 0
    v_mov_b32 v133, 0
    v_mov_b32 v134, 0
    v_mov_b32 v135, 0
    v_mov_b32 v32, v44
    v_mov_b32 v33, v45
    v_mov_b32 v34, v46
    v_mov_b32 v35, v47
    s_waitcnt vmcnt(0)
    s_cmp_ge_u32 s63, 3
    s_cbranch_scc1 L_S_ok
L_S:
    ds_read_b32 v15, v14
    s_waitcnt lgkmcnt(0)
    v_readfirstlane_b32 s63, v15
    s_nop 0
    s_cmp_ge_u32 s63, 3
    s_cbranch_scc1 L_S_ok
    s_sleep 1
    s_branch L_S
L_S_ok:
    s_mov_b32 s35, 0
    buffer_load_dwordx4 v[24:27], v136, s[36:39], s49 offen sc1
    buffer_load_dwordx4 v[28:31], v136, s[36:39], s49 offen offset:256 sc1
    s_cmp_lg_u32 s28, 0
    s_cbranch_scc1 L_noxg
    buffer_load_dwordx4 v[32:35], v154, s[36:39], s50 offen sc1
L_noxg:
    s_mov_b64 exec, 1
    ds_write_b32 v5, v6 offset:96
    s_mov_b64 exec, -1
    s_cmp_ge_u32 s63, 4
    s_cbranch_scc1 L_k_ok
L_k:
    ds_read_b32 v15, v14
    s_waitcnt lgkmcnt(0)
    v_readfirstlane_b32 s63, v15
    s_nop 0
    s_cmp_ge_u32 s63, 4
    s_cbranch_scc1 L_k_ok
    s_sleep 1
    s_branch L_k
L_k_ok:
    ds_read_b128 v[56:59], v138 offset:0
    ds_read_b128 v[60:63], v139 offset:0
    ds_read_b128 v[64:67], v140 offset:0
    ds_read_b128 v[68:71], v141 offset:0
    ds_read_b128 v[72:75], v138 offset:4096
    ds_read_b128 v[76:79], v139 offset:4096
    ds_read_b128 v[80:83], v140 offset:4096
    ds_read_b128 v[84:87], v141 offset:4096
    s_waitcnt vmcnt(0)
    v_bitop3_b32 v36, v24, v25, v9 bitop3:0x7e
    v_bitop3_b32 v37, v26, v27, v9 bitop3:0x7e
    v_bitop3_b32 v38, v28, v29, v9 bitop3:0x7e
    v_or3_b32 v36, v36, v37, v38
    v_bitop3_b32 v37, v30, v31, v9 bitop3:0x7e
    v_bitop3_b32 v38, v32, v33, v9 bitop3:0x7e
    v_or3_b32 v36, v36, v37, v38
    v_bitop3_b32 v37, v34, v35, v9 bitop3:0x7e
    v_or_b32 v36, v36, v37
    v_and_b32 v36, 1023, v36
    v_cmp_ne_u32 vcc, 0, v36
    s_cbranch_vccnz L_qg_retry
L_qg_done:
    v_and_b32 v24, s47, v24
    v_and_b32 v25, s47, v25
    v_and_b32 v26, s47, v26
    v_and_b32 v27, s47, v27
    v_and_b32 v28, s47, v28
    v_and_b32 v29, s47, v29
    v_and_b32 v30, s47, v30
    v_and_b32 v31, s47, v31
    v_lshrrev_b32 v32, 16, v32
    v_permlane16_swap_b32 v24, v28
    v_permlane16_swap_b32 v25, v29
    v_permlane16_swap_b32 v26, v30
    v_permlane16_swap_b32 v27, v31
    v_cmp_ne_u32 vcc, s61, v32
    v_pk_add_f32 v[24:25], v[24:25], v[28:29]
    v_pk_add_f32 v[26:27], v[26:27], v[30:31]
    s_nop 1
    v_permlane32_swap_b32 v24, v26
    v_permlane32_swap_b32 v25, v27
    v_pk_add_f32 v[24:25], v[24:25], v[26:27]
    v_cvt_pk_bf16_f32 v24, v24, v25
    ds_write_b32 v137, v24
    s_cmp_eq_u64 vcc, 0
    s_cselect_b32 s62, 3, 1
    v_mov_b32 v36, s62
    s_mov_b64 exec, 1
    ds_write_b32 v5, v36 offset:16
    s_mov_b64 exec, -1
L_s1:
    ds_read_b128 v[16:19], v14 offset:16
    ds_read_b128 v[40:43], v142 offset:57856
    ds_read_b128 v[44:47], v142 offset:57920
    ds_read_b128 v[48:51], v142 offset:57984
    ds_read_b128 v[52:55], v142 offset:58048
    s_waitcnt lgkmcnt(4)
    v_and_b32 v16, v16, v17
    v_and_b32 v18, v18, v19
    v_and_b32 v16, v16, v18
    s_nop 0
    v_readfirstlane_b32 s34, v16
    s_nop 0
    s_cmp_eq_u32 s34, 0
    s_cbranch_scc1 L_s1
    s_lshr_b32 s62, s34, 1
    s_waitcnt lgkmcnt(3)
    v_mfma_f32_16x16x32_bf16 v[32:35], v[56:59], v[40:43], 0
    v_mfma_f32_16x16x32_bf16 v[36:39], v[72:75], v[40:43], 0
    s_waitcnt lgkmcnt(2)
    v_mfma_f32_16x16x32_bf16 v[32:35], v[60:63], v[44:47], v[32:35]
    v_mfma_f32_16x16x32_bf16 v[36:39], v[76:79], v[44:47], v[36:39]
    s_waitcnt lgkmcnt(1)
    v_mfma_f32_16x16x32_bf16 v[32:35], v[64:67], v[48:51], v[32:35]
    v_mfma_f32_16x16x32_bf16 v[36:39], v[80:83], v[48:51], v[36:39]
    s_waitcnt lgkmcnt(0)
    v_mfma_f32_16x16x32_bf16 v[32:35], v[68:71], v[52:55], v[32:35]
    v_mfma_f32_16x16x32_bf16 v[36:39], v[84:87], v[52:55], v[36:39]
    s_nop 6
    v_cvt_pk_bf16_f32 v33, v32, v33
    v_lshlrev_b32 v32, 16, v33
    v_and_b32 v33, 0xffff0000, v33
    v_cvt_pk_bf16_f32 v35, v34, v35
    v_lshlrev_b32 v34, 16, v35
    v_and_b32 v35, 0xffff0000, v35
    v_cvt_pk_bf16_f32 v37, v36, v37
    v_lshlrev_b32 v36, 16, v37
    v_and_b32 v37, 0xffff0000, v37
    v_cvt_pk_bf16_f32 v39, v38, v39
    v_lshlrev_b32 v38, 16, v39
    v_and_b32 v39, 0xffff0000, v39
    v_pk_mul_f32 v[32:33], v[32:33], s[10:11]
    v_pk_mul_f32 v[34:35], v[34:35], s[10:11]
    v_pk_mul_f32 v[36:37], v[36:37], s[10:11]
    v_pk_mul_f32 v[38:39], v[38:39], s[10:11]
    v_cvt_pk_bf16_f32 v33, v32, v33
    v_lshlrev_b32 v32, 16, v33
    v_and_b32 v33, 0xffff0000, v33
    v_cvt_pk_bf16_f32 v35, v34, v35
    v_lshlrev_b32 v34, 16, v35
    v_and_b32 v35, 0xffff0000, v35
    v_cvt_pk_bf16_f32 v37, v36, v37
    v_lshlrev_b32 v36, 16, v37
    v_and_b32 v37, 0xffff0000, v37
    v_cvt_pk_bf16_f32 v39, v38, v39
    v_lshlrev_b32 v38, 16, v39
    v_and_b32 v39, 0xffff0000, v39
    v_max3_f32 v40, v32, v33, v34
    v_max3_f32 v41, v35, v36, v37
    v_max3_f32 v40, v40, v38, v39
    v_max_f32 v40, v40, v41
    v_mov_b32 v41, v40
    s_nop 1
    v_permlane16_swap_b32 v41, v40
    v_max_f32 v40, v40, v41
    v_mov_b32 v41, v40
    s_nop 1
    v_permlane32_swap_b32 v41, v40
    v_max_f32 v40, v40, v41
    v_mul_f32 v40, s46, v40
    v_fma_f32 v32, v32, s46, -v40
    v_fma_f32 v33, v33, s46, -v40
    v_fma_f32 v34, v34, s46, -v40
    v_fma_f32 v35, v35, s46, -v40
    v_fma_f32 v36, v36, s46, -v40
    v_fma_f32 v37, v37, s46, -v40
    v_fma_f32 v38, v38, s46, -v40
    v_fma_f32 v39, v39, s46, -v40
    v_exp_f32 v32, v32
    v_exp_f32 v33, v33
    v_exp_f32 v34, v34
    v_exp_f32 v35, v35
    v_exp_f32 v36, v36
    v_exp_f32 v37, v37
    v_exp_f32 v38, v38
    v_exp_f32 v39, v39
    v_pk_add_f32 v[42:43], v[32:33], v[34:35]
    v_pk_add_f32 v[44:45], v[36:37], v[38:39]
    v_cvt_pk_bf16_f32 v32, v32, v33
    v_cvt_pk_bf16_f32 v33, v34, v35
    v_cvt_pk_bf16_f32 v34, v36, v37
    v_cvt_pk_bf16_f32 v35, v38, v39
    ds_write_b128 v143, v[32:35]
    s_mov_b64 exec, 1
    ds_write_b32 v5, v6 offset:32
    s_mov_b64 exec, -1
    v_pk_add_f32 v[42:43], v[42:43], v[44:45]
    v_add_f32 v41, v42, v43
    v_mov_b32 v42, v41
    s_nop 1
    v_permlane16_swap_b32 v42, v41
    v_add_f32 v41, v41, v42
    v_mov_b32 v42, v41
    s_nop 1
    v_permlane32_swap_b32 v42, v41
    v_add_f32 v41, v41, v42
    ds_write_b64 v144, v[40:41]
    s_mov_b64 exec, 1
    ds_write_b32 v5, v6 offset:80
    s_mov_b64 exec, -1
L_s2:
    ds_read_b32 v15, v14
    ds_read_b128 v[16:19], v14 offset:32
    s_mov_b64 exec, s[16:17]
    ds_read_b128 v[104:107], v155 offset:0
    ds_read_b128 v[112:115], v155 offset:1024
    ds_read_b128 v[120:123], v155 offset:2048
    ds_read_b128 v[128:131], v155 offset:3072
    s_mov_b64 exec, s[18:19]
    ds_read_b128 v[108:111], v155 offset:0
    ds_read_b128 v[116:119], v155 offset:1024
    ds_read_b128 v[124:127], v155 offset:2048
    ds_read_b128 v[132:135], v155 offset:3072
    s_mov_b64 exec, -1
    s_waitcnt lgkmcnt(8)
    v_and_b32 v16, v16, v17
    v_and_b32 v18, v18, v19
    v_and_b32 v16, v16, v18
    v_readfirstlane_b32 s63, v15
    v_readfirstlane_b32 s34, v16
    s_nop 0
    s_cmp_eq_u32 s34, 0
    s_cbranch_scc1 L_s2
    s_cmp_ge_u32 s63, 7
    s_cbranch_scc1 L_v0_ok
L_v0:
    ds_read_b32 v15, v14
    s_waitcnt lgkmcnt(0)
    v_readfirstlane_b32 s63, v15
    s_nop 0
    s_cmp_ge_u32 s63, 7
    s_cbranch_scc0 L_v0
L_v0_ok:
    ds_read_b64_tr_b16 v[24:25], v146 offset:0
    ds_read_b64_tr_b16 v[26:27], v146 offset:4096
    ds_read_b64_tr_b16 v[28:29], v147 offset:0
    ds_read_b64_tr_b16 v[30:31], v147 offset:4096
    s_cmp_ge_u32 s63, 8
    s_cbranch_scc1 L_v1_ok
L_v1:
    ds_read_b32 v15, v14
    s_waitcnt lgkmcnt(0)
    v_readfirstlane_b32 s63, v15
    s_nop 0
    s_cmp_ge_u32 s63, 8
    s_cbranch_scc0 L_v1
L_v1_ok:
    ds_read_b64_tr_b16 v[32:33], v146 offset:8192
    ds_read_b64_tr_b16 v[34:35], v146 offset:12288
    ds_read_b64_tr_b16 v[36:37], v147 offset:8192
    ds_read_b64_tr_b16 v[38:39], v147 offset:12288
    s_waitcnt lgkmcnt(6)
    v_mfma_f32_16x16x32_bf16 v[56:59], v[24:27], v[104:107], 0
    s_waitcnt lgkmcnt(4)
    v_mfma_f32_16x16x32_bf16 v[56:59], v[28:31], v[108:111], v[56:59]
L_sm:
    ds_read_b32 v15, v14
    ds_read_b128 v[16:19], v14 offset:80
    ds_read_b64 v[76:77], v145 offset:0
    ds_read_b64 v[78:79], v145 offset:512
    ds_read_b64 v[80:81], v145 offset:1024
    ds_read_b64 v[82:83], v145 offset:1536
    s_waitcnt lgkmcnt(4)
    v_and_b32 v16, v16, v17
    v_and_b32 v18, v18, v19
    v_and_b32 v16, v16, v18
    v_readfirstlane_b32 s63, v15
    v_readfirstlane_b32 s34, v16
    s_nop 0
    s_cmp_eq_u32 s34, 0
    s_cbranch_scc1 L_sm
    s_waitcnt lgkmcnt(0)
    v_max3_f32 v46, v76, v78, v80
    v_max_f32 v46, v46, v82
    v_sub_f32 v76, v76, v46
    v_sub_f32 v78, v78, v46
    v_sub_f32 v80, v80, v46
    v_sub_f32 v82, v82, v46
    v_exp_f32 v76, v76
    v_exp_f32 v78, v78
    v_exp_f32 v80, v80
    v_exp_f32 v82, v82
    s_and_b32 s34, s44, 0x1fffff
    v_mov_b32 v7, s34
    v_mul_f32 v41, v76, v77
    v_fmac_f32 v41, v78, v79
    v_fmac_f32 v41, v80, v81
    v_fmac_f32 v41, v82, v83
    v_log_f32 v54, v41
    v_rcp_f32 v52, v41
    s_mov_b32 s34, 0xffe00000
    v_add_f32 v54, v54, v46
    v_mul_f32 v76, v76, v52
    v_mul_f32 v78, v78, v52
    v_mul_f32 v80, v80, v52
    v_mul_f32 v82, v82, v52
    v_add_u32 v54, 0x200, v54
    v_and_or_b32 v53, v54, s34, v7
    v_lshlrev_b32 v54, 11, v54
    v_and_or_b32 v55, v54, s34, v7
    s_cmp_ge_u32 s63, 9
    s_cbranch_scc1 L_v2_ok
L_v2:
    ds_read_b32 v15, v14
    s_waitcnt lgkmcnt(0)
    v_readfirstlane_b32 s63, v15
    s_nop 0
    s_cmp_ge_u32 s63, 9
    s_cbranch_scc0 L_v2
L_v2_ok:
    ds_read_b64_tr_b16 v[24:25], v146 offset:16384
    ds_read_b64_tr_b16 v[26:27], v146 offset:20480
    ds_read_b64_tr_b16 v[28:29], v147 offset:16384
    ds_read_b64_tr_b16 v[30:31], v147 offset:20480
    s_waitcnt lgkmcnt(6)
    v_mfma_f32_16x16x32_bf16 v[60:63], v[32:35], v[112:115], 0
    s_waitcnt lgkmcnt(4)
    v_mfma_f32_16x16x32_bf16 v[60:63], v[36:39], v[116:119], v[60:63]
    v_pk_mul_f32 v[48:49], v[56:57], v[76:77] op_sel_hi:[1,0]
    v_pk_mul_f32 v[50:51], v[58:59], v[76:77] op_sel_hi:[1,0]
    s_cmp_ge_u32 s63, 10
    s_cbranch_scc1 L_v3_ok
L_v3:
    ds_read_b32 v15, v14
    s_waitcnt lgkmcnt(0)
    v_readfirstlane_b32 s63, v15
    s_nop 0
    s_cmp_ge_u32 s63, 10
    s_cbranch_scc0 L_v3
L_v3_ok:
    ds_read_b64_tr_b16 v[32:33], v146 offset:24576
    ds_read_b64_tr_b16 v[34:35], v146 offset:28672
    ds_read_b64_tr_b16 v[36:37], v147 offset:24576
    ds_read_b64_tr_b16 v[38:39], v147 offset:28672
    s_waitcnt lgkmcnt(6)
    v_mfma_f32_16x16x32_bf16 v[64:67], v[24:27], v[120:123], 0
    s_waitcnt lgkmcnt(4)
    v_mfma_f32_16x16x32_bf16 v[64:67], v[28:31], v[124:127], v[64:67]
    v_pk_fma_f32 v[48:49], v[60:61], v[78:79], v[48:49] op_sel_hi:[1,0,1]
    v_pk_fma_f32 v[50:51], v[62:63], v[78:79], v[50:51] op_sel_hi:[1,0,1]
    s_waitcnt lgkmcnt(2)
    v_mfma_f32_16x16x32_bf16 v[68:71], v[32:35], v[128:131], 0
    s_waitcnt lgkmcnt(0)
    v_mfma_f32_16x16x32_bf16 v[68:71], v[36:39], v[132:135], v[68:71]
    s_nop 1
    v_pk_fma_f32 v[48:49], v[64:65], v[80:81], v[48:49] op_sel_hi:[1,0,1]
    v_pk_fma_f32 v[50:51], v[66:67], v[80:81], v[50:51] op_sel_hi:[1,0,1]
    s_mov_b64 exec, s[14:15]
    s_nop 2
    v_pk_fma_f32 v[48:49], v[68:69], v[82:83], v[48:49] op_sel_hi:[1,0,1]
    v_pk_fma_f32 v[50:51], v[70:71], v[82:83], v[50:51] op_sel_hi:[1,0,1]
    v_cvt_pk_bf16_f32 v52, v48, v49
    v_cvt_pk_bf16_f32 v54, v50, v51
    s_cmp_eq_u32 s62, 0
    s_cbranch_scc1 L_ps1
    buffer_store_dwordx4 v[52:55], v148, s[36:39], s53 offen
L_pd1:
    s_mov_b64 exec, -1
    s_mov_b32 s34, 0xffe00000
    s_mov_b32 s35, 0
    buffer_load_dwordx4 v[24:27], v149, s[36:39], s56 offen sc1 nt
    buffer_load_dwordx4 v[28:31], v149, s[36:39], s57 offen sc1 nt
    buffer_load_dwordx4 v[32:35], v149, s[36:39], s4 offen sc1 nt
    buffer_load_dwordx4 v[36:39], v149, s[36:39], s5 offen sc1 nt
    s_cmp_ge_u32 s63, 6
    s_cbranch_scc1 L_wo_ok
L_wo:
    ds_read_b32 v15, v14
    s_waitcnt lgkmcnt(0)
    v_readfirstlane_b32 s63, v15
    s_nop 0
    s_cmp_ge_u32 s63, 6
    s_cbranch_scc0 L_wo
L_wo_ok:
    ds_read_b64_tr_b16 v[88:89], v153 offset:32768
    ds_read_b64_tr_b16 v[90:91], v153 offset:34816
    ds_read_b64_tr_b16 v[92:93], v153 offset:36864
    ds_read_b64_tr_b16 v[94:95], v153 offset:38912
    ds_read_b64_tr_b16 v[96:97], v153 offset:40960
    ds_read_b64_tr_b16 v[98:99], v153 offset:43008
    ds_read_b64_tr_b16 v[100:101], v153 offset:45056
    ds_read_b64_tr_b16 v[102:103], v153 offset:47104
    s_waitcnt vmcnt(0)
    v_bitop3_b32 v40, v25, v27, v7 bitop3:0x7e
    v_bitop3_b32 v41, v29, v31, v7 bitop3:0x7e
    v_bitop3_b32 v42, v33, v35, v7 bitop3:0x7e
    v_bitop3_b32 v43, v37, v39, v7 bitop3:0x7e
    v_or3_b32 v40, v40, v41, v42
    v_or_b32 v40, v40, v43
    v_lshlrev_b32 v40, 11, v40
    v_cmp_ne_u32 vcc, 0, v40
    s_cbranch_vccnz L_og_retry
L_og_done:
    v_lshrrev_b32 v27, 11, v27
    v_lshrrev_b32 v31, 11, v31
    v_lshrrev_b32 v35, 11, v35
    v_lshrrev_b32 v39, 11, v39
    v_bfi_b32 v27, s34, v25, v27
    v_bfi_b32 v31, s34, v29, v31
    v_bfi_b32 v35, s34, v33, v35
    v_bfi_b32 v39, s34, v37, v39
    v_and_b32 v25, s47, v27
    v_and_b32 v29, s47, v31
    v_and_b32 v33, s47, v35
    v_and_b32 v37, s47, v39
    v_max3_f32 v40, v25, v29, v33
    v_max_f32 v40, v40, v37
    v_lshlrev_b32 v56, 16, v24
    v_and_b32 v57, 0xffff0000, v24
    v_max_f32_dpp v40, v40, v40 row_ror:8 row_mask:0xf bank_mask:0xf
    v_mov_b32 v41, v40
    v_lshlrev_b32 v58, 16, v26
    v_and_b32 v59, 0xffff0000, v26
    v_permlane16_swap_b32 v41, v40
    v_max_f32 v40, v40, v41
    v_mov_b32 v41, v40
    v_lshlrev_b32 v60, 16, v28
    v_and_b32 v61, 0xffff0000, v28
    v_permlane32_swap_b32 v41, v40
    v_max_f32 v40, v40, v41
    v_sub_f32 v72, v25, v40
    v_sub_f32 v74, v29, v40
    v_sub_f32 v76, v33, v40
    v_sub_f32 v78, v37, v40
    v_exp_f32 v72, v72
    v_exp_f32 v74, v74
    v_exp_f32 v76, v76
    v_exp_f32 v78, v78
    v_lshlrev_b32 v62, 16, v30
    v_and_b32 v63, 0xffff0000, v30
    v_lshlrev_b32 v64, 16, v32
    v_and_b32 v65, 0xffff0000, v32
    v_lshlrev_b32 v66, 16, v34
    v_and_b32 v67, 0xffff0000, v34
    v_lshlrev_b32 v68, 16, v36
    v_and_b32 v69, 0xffff0000, v36
    v_lshlrev_b32 v70, 16, v38
    v_and_b32 v71, 0xffff0000, v38
    v_add_f32 v40, v72, v74
    v_add_f32 v41, v76, v78
    v_pk_mul_f32 v[56:57], v[56:57], v[72:73] op_sel_hi:[1,0]
    v_pk_mul_f32 v[58:59], v[58:59], v[72:73] op_sel_hi:[1,0]
    v_add_f32 v40, v40, v41
    v_pk_fma_f32 v[56:57], v[60:61], v[74:75], v[56:57] op_sel_hi:[1,0,1]
    v_pk_fma_f32 v[58:59], v[62:63], v[74:75], v[58:59] op_sel_hi:[1,0,1]
    v_add_f32_dpp v40, v40, v40 row_ror:8 row_mask:0xf bank_mask:0xf
    v_pk_fma_f32 v[56:57], v[64:65], v[76:77], v[56:57] op_sel_hi:[1,0,1]
    v_pk_fma_f32 v[58:59], v[66:67], v[76:77], v[58:59] op_sel_hi:[1,0,1]
    v_mov_b32 v41, v40
    v_pk_fma_f32 v[56:57], v[68:69], v[78:79], v[56:57] op_sel_hi:[1,0,1]
    v_pk_fma_f32 v[58:59], v[70:71], v[78:79], v[58:59] op_sel_hi:[1,0,1]
    v_permlane16_swap_b32 v41, v40
    v_add_f32 v40, v40, v41
    v_mov_b32 v41, v40
    v_add_f32_dpp v56, v56, v56 row_ror:8 row_mask:0xf bank_mask:0x3
    v_add_f32_dpp v57, v57, v57 row_ror:8 row_mask:0xf bank_mask:0x3
    v_permlane32_swap_b32 v41, v40
    v_add_f32_dpp v56, v58, v58 row_ror:8 row_mask:0xf bank_mask:0xc
    v_add_f32_dpp v57, v59, v59 row_ror:8 row_mask:0xf bank_mask:0xc
    v_add_f32 v40, v40, v41
    v_rcp_f32 v40, v40
    v_permlane16_swap_b32 v56, v57
    v_add_f32 v56, v56, v57
    v_mov_b32 v57, v56
    s_nop 1
    v_permlane32_swap_b32 v57, v56
    v_add_f32 v56, v56, v57
    v_mul_f32 v56, v56, v40
    v_cvt_pk_bf16_f32 v56, v56, v56
    ds_write_b16 v151, v56
    s_waitcnt lgkmcnt(0)
    s_barrier
    ds_read_b128 v[24:27], v152 offset:57600
    ds_read_b128 v[28:31], v152 offset:57664
    ds_read_b128 v[32:35], v152 offset:57728
    ds_read_b128 v[36:39], v152 offset:57792
    s_waitcnt lgkmcnt(3)
    v_mfma_f32_16x16x32_bf16 v[40:43], v[88:91], v[24:27], 0
    s_waitcnt lgkmcnt(2)
    v_mfma_f32_16x16x32_bf16 v[40:43], v[92:95], v[28:31], v[40:43]
    s_waitcnt lgkmcnt(1)
    v_mfma_f32_16x16x32_bf16 v[40:43], v[96:99], v[32:35], v[40:43]
    s_waitcnt lgkmcnt(0)
    v_mfma_f32_16x16x32_bf16 v[40:43], v[100:103], v[36:39], v[40:43]
    s_mov_b64 exec, s[54:55]
    s_nop 6
    v_and_or_b32 v40, v40, s47, v9
    v_and_or_b32 v41, v41, s47, v9
    v_and_or_b32 v42, v42, s47, v9
    v_and_or_b32 v43, v43, s47, v9
    buffer_store_dwordx4 v[40:43], v152, s[36:39], s59 offen sc1
    s_endpgm
L_og_retry:
    s_mov_b64 exec, vcc
    buffer_load_dwordx4 v[24:27], v149, s[36:39], s56 offen sc1 nt
    buffer_load_dwordx4 v[28:31], v149, s[36:39], s57 offen sc1 nt
    buffer_load_dwordx4 v[32:35], v149, s[36:39], s4 offen sc1 nt
    buffer_load_dwordx4 v[36:39], v149, s[36:39], s5 offen sc1 nt
    s_mov_b64 exec, -1
    s_add_u32 s35, s35, 1
    s_cmp_ge_u32 s35, 300000
    s_waitcnt vmcnt(0)
    s_cbranch_scc1 L_og_done
    v_bitop3_b32 v40, v25, v27, v7 bitop3:0x7e
    v_bitop3_b32 v41, v29, v31, v7 bitop3:0x7e
    v_bitop3_b32 v42, v33, v35, v7 bitop3:0x7e
    v_bitop3_b32 v43, v37, v39, v7 bitop3:0x7e
    v_or3_b32 v40, v40, v41, v42
    v_or_b32 v40, v40, v43
    v_lshlrev_b32 v40, 11, v40
    v_cmp_ne_u32 vcc, 0, v40
    s_cbranch_vccnz L_og_retry
    s_branch L_og_done
L_ps1:
    buffer_store_dwordx4 v[52:55], v148, s[36:39], s53 offen sc1
    s_branch L_pd1
L_qg_retry:
    s_mov_b64 exec, vcc
    buffer_load_dwordx4 v[24:27], v136, s[36:39], s49 offen sc1
    buffer_load_dwordx4 v[28:31], v136, s[36:39], s49 offen offset:256 sc1
    buffer_load_dwordx4 v[32:35], v154, s[36:39], s50 offen sc1
    s_mov_b64 exec, -1
    s_add_u32 s35, s35, 1
    s_cmp_ge_u32 s35, 300000
    s_waitcnt vmcnt(0)
    s_cbranch_scc1 L_qg_done
    v_bitop3_b32 v36, v24, v25, v9 bitop3:0x7e
    v_bitop3_b32 v37, v26, v27, v9 bitop3:0x7e
    v_bitop3_b32 v38, v28, v29, v9 bitop3:0x7e
    v_or3_b32 v36, v36, v37, v38
    v_bitop3_b32 v37, v30, v31, v9 bitop3:0x7e
    v_bitop3_b32 v38, v32, v33, v9 bitop3:0x7e
    v_or3_b32 v36, v36, v37, v38
    v_bitop3_b32 v37, v34, v35, v9 bitop3:0x7e
    v_or_b32 v36, v36, v37
    v_and_b32 v36, 1023, v36
    v_cmp_ne_u32 vcc, 0, v36
    s_cbranch_vccnz L_qg_retry
    s_branch L_qg_done
L_ffn:
    s_mov_b32 s54, 0x000f000f
    s_mov_b32 s55, 0x000f000f
    s_mul_i32 s60, s33, 7
    s_add_u32 s60, s60, s32
    s_cmp_gt_u32 s32, 3
    s_subb_u32 s60, s60, 0
    s_and_b32 s61, s60, 7
    s_lshr_b32 s60, s60, 3
    s_cmp_eq_u32 s32, 3
    s_cbranch_scc1 L_final
    s_mov_b32 s48, 0x22222222
    s_mov_b32 s49, 0x22222222
    s_mov_b32 s50, 0x44444444
    s_mov_b32 s51, 0x44444444
    s_mov_b32 s52, 0x88888888
    s_mov_b32 s53, 0x88888888
    s_lshl_b32 s34, s61, 7
    s_add_u32 s34, s34, s46
    v_lshl_add_u32 v128, v3, 3, s34
    v_lshl_add_u32 v133, v3, 3, s46
    v_lshlrev_b32 v129, 6, v2
    v_lshl_add_u32 v129, v3, 4, v129
    v_lshlrev_b32 v132, 11, v2
    v_lshl_add_u32 v132, v3, 4, v132
    s_lshl_b32 s56, s60, 12
    s_add_u32 s56, s56, 131072
    s_lshl_b32 s35, s61, 9
    s_add_u32 s57, s56, s35
    v_lshrrev_b32 v17, 1, v3
    v_lshlrev_b32 v131, 2, v17
    v_lshl_add_u32 v131, v2, 3, v131
    v_add_u32 v131, s46, v131
    s_lshl_b32 s58, s61, 13
    s_lshl_b32 s35, s60, 6
    s_add_u32 s58, s58, s35
    s_add_u32 s58, s58, 393216
    s_waitcnt vmcnt(0)
    s_waitcnt lgkmcnt(0)
    s_add_u32 s44, s44, 1
    s_and_b32 s45, s44, 1023
    v_mov_b32 v9, s45
    v_lshlrev_b32 v24, 16, v20
    v_and_b32 v25, 0xffff0000, v20
    v_lshlrev_b32 v26, 16, v21
    v_and_b32 v27, 0xffff0000, v21
    v_lshlrev_b32 v28, 16, v22
    v_and_b32 v29, 0xffff0000, v22
    v_lshlrev_b32 v30, 16, v23
    v_and_b32 v31, 0xffff0000, v23
    v_pk_add_f32 v[32:33], v[24:25], v[26:27]
    v_pk_add_f32 v[34:35], v[28:29], v[30:31]
    v_pk_add_f32 v[32:33], v[32:33], v[34:35]
    v_add_f32 v32, v32, v33
    s_nop 1
    v_add_f32_dpp v32, v32, v32 row_ror:8 row_mask:0xf bank_mask:0xf
    s_nop 1
    v_add_f32_dpp v32, v32, v32 row_ror:4 row_mask:0xf bank_mask:0xf
    s_nop 1
    v_add_f32_dpp v32, v32, v32 row_ror:2 row_mask:0xf bank_mask:0xf
    s_nop 1
    v_add_f32_dpp v32, v32, v32 row_ror:1 row_mask:0xf bank_mask:0xf
    v_mov_b32 v33, v32
    s_nop 1
    v_permlane16_swap_b32 v33, v32
    v_add_f32 v32, v32, v33
    v_mov_b32 v33, v32
    s_nop 1
    v_permlane32_swap_b32 v33, v32
    v_add_f32 v32, v32, v33
    v_mul_f32 v32, 0x3b000000, v32
    v_pk_add_f32 v[36:37], v[24:25], v[32:33] op_sel_hi:[1,0] neg_lo:[0,1] neg_hi:[0,1]
    v_pk_add_f32 v[38:39], v[26:27], v[32:33] op_sel_hi:[1,0] neg_lo:[0,1] neg_hi:[0,1]
    v_pk_add_f32 v[40:41], v[28:29], v[32:33] op_sel_hi:[1,0] neg_lo:[0,1] neg_hi:[0,1]
    v_pk_add_f32 v[42:43], v[30:31], v[32:33] op_sel_hi:[1,0] neg_lo:[0,1] neg_hi:[0,1]
    v_pk_mul_f32 v[34:35], v[36:37], v[36:37]
    v_pk_fma_f32 v[34:35], v[38:39], v[38:39], v[34:35]
    v_pk_fma_f32 v[34:35], v[40:41], v[40:41], v[34:35]
    v_pk_fma_f32 v[34:35], v[42:43], v[42:43], v[34:35]
    v_add_f32 v33, v34, v35
    s_nop 1
    v_add_f32_dpp v33, v33, v33 row_ror:8 row_mask:0xf bank_mask:0xf
    s_nop 1
    v_add_f32_dpp v33, v33, v33 row_ror:4 row_mask:0xf bank_mask:0xf
    s_nop 1
    v_add_f32_dpp v33, v33, v33 row_ror:2 row_mask:0xf bank_mask:0xf
    s_nop 1
    v_add_f32_dpp v33, v33, v33 row_ror:1 row_mask:0xf bank_mask:0xf
    v_mov_b32 v34, v33
    s_nop 1
    v_permlane16_swap_b32 v34, v33
    v_add_f32 v33, v33, v34
    v_mov_b32 v34, v33
    s_nop 1
    v_permlane32_swap_b32 v34, v33
    v_add_f32 v33, v33, v34
    v_mul_f32 v33, 0x3b000000, v33
    v_cvt_pk_bf16_f32 v33, v32, v33
    v_lshlrev_b32 v32, 16, v33
    v_and_b32 v33, 0xffff0000, v33
    v_add_f32 v34, 0x3727c5ac, v33
    v_pk_add_f32 v[24:25], v[24:25], v[32:33] op_sel_hi:[1,0] neg_lo:[0,1] neg_hi:[0,1]
    v_pk_add_f32 v[26:27], v[26:27], v[32:33] op_sel_hi:[1,0] neg_lo:[0,1] neg_hi:[0,1]
    v_cvt_pk_bf16_f32 v34, v34, v34
    v_lshlrev_b32 v34, 16, v34
    v_sqrt_f32 v34, v34
    v_pk_add_f32 v[28:29], v[28:29], v[32:33] op_sel_hi:[1,0] neg_lo:[0,1] neg_hi:[0,1]
    v_pk_add_f32 v[30:31], v[30:31], v[32:33] op_sel_hi:[1,0] neg_lo:[0,1] neg_hi:[0,1]
    v_cvt_pk_bf16_f32 v34, v34, v34
    v_lshlrev_b32 v34, 16, v34
    v_rcp_f32 v44, v34
    v_cvt_pk_bf16_f32 v25, v24, v25
    v_lshlrev_b32 v24, 16, v25
    v_and_b32 v25, 0xffff0000, v25
    v_cvt_pk_bf16_f32 v27, v26, v27
    v_lshlrev_b32 v26, 16, v27
    v_and_b32 v27, 0xffff0000, v27
    v_cvt_pk_bf16_f32 v29, v28, v29
    v_lshlrev_b32 v28, 16, v29
    v_and_b32 v29, 0xffff0000, v29
    v_cvt_pk_bf16_f32 v31, v30, v31
    v_lshlrev_b32 v30, 16, v31
    v_and_b32 v31, 0xffff0000, v31
    v_pk_mul_f32 v[36:37], v[24:25], v[44:45] op_sel_hi:[1,0]
    v_pk_mul_f32 v[38:39], v[26:27], v[44:45] op_sel_hi:[1,0]
    v_pk_mul_f32 v[40:41], v[28:29], v[44:45] op_sel_hi:[1,0]
    v_pk_mul_f32 v[42:43], v[30:31], v[44:45] op_sel_hi:[1,0]
    v_pk_fma_f32 v[24:25], v[36:37], v[34:35], v[24:25] op_sel_hi:[1,0,1] neg_lo:[1,0,0] neg_hi:[1,0,0]
    v_pk_fma_f32 v[26:27], v[38:39], v[34:35], v[26:27] op_sel_hi:[1,0,1] neg_lo:[1,0,0] neg_hi:[1,0,0]
    v_pk_fma_f32 v[28:29], v[40:41], v[34:35], v[28:29] op_sel_hi:[1,0,1] neg_lo:[1,0,0] neg_hi:[1,0,0]
    v_pk_fma_f32 v[30:31], v[42:43], v[34:35], v[30:31] op_sel_hi:[1,0,1] neg_lo:[1,0,0] neg_hi:[1,0,0]
    v_pk_fma_f32 v[36:37], v[24:25], v[44:45], v[36:37] op_sel_hi:[1,0,1]
    v_pk_fma_f32 v[38:39], v[26:27], v[44:45], v[38:39] op_sel_hi:[1,0,1]
    v_pk_fma_f32 v[40:41], v[28:29], v[44:45], v[40:41] op_sel_hi:[1,0,1]
    v_pk_fma_f32 v[42:43], v[30:31], v[44:45], v[42:43] op_sel_hi:[1,0,1]
    v_cvt_pk_bf16_f32 v24, v36, v37
    v_cvt_pk_bf16_f32 v25, v38, v39
    v_cvt_pk_bf16_f32 v26, v40, v41
    v_cvt_pk_bf16_f32 v27, v42, v43
    ds_write_b128 v7, v[24:27]
    ds_read2_b64 v[24:27], v128 offset0:0 offset1:4
    ds_read2_b64 v[28:31], v128 offset0:8 offset1:12
    s_cmp_ge_u32 s63, 2
    s_cbranch_scc1 L_gu_ok
L_gu:
    ds_read_b32 v15, v14
    s_waitcnt lgkmcnt(0)
    v_readfirstlane_b32 s63, v15
    s_nop 0
    s_cmp_ge_u32 s63, 2
    s_cbranch_scc1 L_gu_ok
    s_sleep 1
    s_branch L_gu
L_gu_ok:
    ds_read_b64_tr_b16 v[64:65], v10 offset:16384
    ds_read_b64_tr_b16 v[66:67], v10 offset:18432
    ds_read_b64_tr_b16 v[68:69], v11 offset:16384
    ds_read_b64_tr_b16 v[70:71], v11 offset:18432
    ds_read_b64_tr_b16 v[72:73], v12 offset:16384
    ds_read_b64_tr_b16 v[74:75], v12 offset:18432
    ds_read_b64_tr_b16 v[76:77], v13 offset:16384
    ds_read_b64_tr_b16 v[78:79], v13 offset:18432
    ds_read_b64_tr_b16 v[80:81], v10 offset:20480
    ds_read_b64_tr_b16 v[82:83], v10 offset:22528
    ds_read_b64_tr_b16 v[84:85], v11 offset:20480
    ds_read_b64_tr_b16 v[86:87], v11 offset:22528
    ds_read_b64_tr_b16 v[88:89], v12 offset:20480
    ds_read_b64_tr_b16 v[90:91], v12 offset:22528
    ds_read_b64_tr_b16 v[92:93], v13 offset:20480
    ds_read_b64_tr_b16 v[94:95], v13 offset:22528
    s_waitcnt lgkmcnt(14)
    v_mfma_f32_16x16x32_bf16 v[32:35], v[64:67], v[24:27], 0
    s_waitcnt lgkmcnt(12)
    v_mfma_f32_16x16x32_bf16 v[36:39], v[68:71], v[24:27], 0
    s_waitcnt lgkmcnt(10)
    v_mfma_f32_16x16x32_bf16 v[40:43], v[72:75], v[24:27], 0
    s_waitcnt lgkmcnt(8)
    v_mfma_f32_16x16x32_bf16 v[44:47], v[76:79], v[24:27], 0
    s_waitcnt lgkmcnt(6)
    v_mfma_f32_16x16x32_bf16 v[32:35], v[80:83], v[28:31], v[32:35]
    s_waitcnt lgkmcnt(4)
    v_mfma_f32_16x16x32_bf16 v[36:39], v[84:87], v[28:31], v[36:39]
    s_waitcnt lgkmcnt(2)
    v_mfma_f32_16x16x32_bf16 v[40:43], v[88:91], v[28:31], v[40:43]
    s_waitcnt lgkmcnt(0)
    v_mfma_f32_16x16x32_bf16 v[44:47], v[92:95], v[28:31], v[44:47]
    ds_read_b64_tr_b16 v[96:97], v10 offset:24576
    ds_read_b64_tr_b16 v[98:99], v10 offset:26624
    ds_read_b64_tr_b16 v[100:101], v11 offset:24576
    ds_read_b64_tr_b16 v[102:103], v11 offset:26624
    ds_read_b64_tr_b16 v[104:105], v12 offset:24576
    ds_read_b64_tr_b16 v[106:107], v12 offset:26624
    ds_read_b64_tr_b16 v[108:109], v13 offset:24576
    ds_read_b64_tr_b16 v[110:111], v13 offset:26624
    ds_read_b64_tr_b16 v[112:113], v10 offset:28672
    ds_read_b64_tr_b16 v[114:115], v10 offset:30720
    ds_read_b64_tr_b16 v[116:117], v11 offset:28672
    ds_read_b64_tr_b16 v[118:119], v11 offset:30720
    ds_read_b64_tr_b16 v[120:121], v12 offset:28672
    ds_read_b64_tr_b16 v[122:123], v12 offset:30720
    ds_read_b64_tr_b16 v[124:125], v13 offset:28672
    ds_read_b64_tr_b16 v[126:127], v13 offset:30720
    s_waitcnt lgkmcnt(14)
    v_mfma_f32_16x16x32_bf16 v[48:51], v[96:99], v[24:27], 0
    s_waitcnt lgkmcnt(12)
    v_mfma_f32_16x16x32_bf16 v[52:55], v[100:103], v[24:27], 0
    s_waitcnt lgkmcnt(10)
    v_mfma_f32_16x16x32_bf16 v[56:59], v[104:107], v[24:27], 0
    s_waitcnt lgkmcnt(8)
    v_mfma_f32_16x16x32_bf16 v[60:63], v[108:111], v[24:27], 0
    s_waitcnt lgkmcnt(6)
    v_mfma_f32_16x16x32_bf16 v[48:51], v[112:115], v[28:31], v[48:51]
    s_waitcnt lgkmcnt(4)
    v_mfma_f32_16x16x32_bf16 v[52:55], v[116:119], v[28:31], v[52:55]
    s_waitcnt lgkmcnt(2)
    v_mfma_f32_16x16x32_bf16 v[56:59], v[120:123], v[28:31], v[56:59]
    s_waitcnt lgkmcnt(0)
    v_mfma_f32_16x16x32_bf16 v[60:63], v[124:127], v[28:31], v[60:63]
    v_cndmask_b32 v32, v32, v36, s[48:49]
    v_cndmask_b32 v33, v33, v37, s[48:49]
    v_cndmask_b32 v34, v34, v38, s[48:49]
    v_cndmask_b32 v35, v35, v39, s[48:49]
    v_cndmask_b32 v32, v32, v40, s[50:51]
    v_cndmask_b32 v33, v33, v41, s[50:51]
    v_cndmask_b32 v34, v34, v42, s[50:51]
    v_cndmask_b32 v35, v35, v43, s[50:51]
    v_cndmask_b32 v32, v32, v44, s[52:53]
    v_cndmask_b32 v33, v33, v45, s[52:53]
    v_cndmask_b32 v34, v34, v46, s[52:53]
    v_cndmask_b32 v35, v35, v47, s[52:53]
    v_cndmask_b32 v48, v48, v52, s[48:49]
    v_cndmask_b32 v49, v49, v53, s[48:49]
    v_cndmask_b32 v50, v50, v54, s[48:49]
    v_cndmask_b32 v51, v51, v55, s[48:49]
    v_cndmask_b32 v48, v48, v56, s[50:51]
    v_cndmask_b32 v49, v49, v57, s[50:51]
    v_cndmask_b32 v50, v50, v58, s[50:51]
    v_cndmask_b32 v51, v51, v59, s[50:51]
    v_cndmask_b32 v48, v48, v60, s[52:53]
    v_cndmask_b32 v49, v49, v61, s[52:53]
    v_cndmask_b32 v50, v50, v62, s[52:53]
    v_cndmask_b32 v51, v51, v63, s[52:53]
    v_add_u32 v32, 512, v32
    v_add_u32 v33, 512, v33
    v_add_u32 v34, 512, v34
    v_add_u32 v35, 512, v35
    v_add_u32 v48, 512, v48
    v_add_u32 v49, 512, v49
    v_add_u32 v50, 512, v50
    v_add_u32 v51, 512, v51
    v_and_or_b32 v32, v32, s47, v9
    v_and_or_b32 v33, v33, s47, v9
    v_and_or_b32 v34, v34, s47, v9
    v_and_or_b32 v35, v35, s47, v9
    v_and_or_b32 v48, v48, s47, v9
    v_and_or_b32 v49, v49, s47, v9
    v_and_or_b32 v50, v50, s47, v9
    v_and_or_b32 v51, v51, s47, v9
    s_mov_b64 exec, s[54:55]
    buffer_store_dwordx4 v[32:35], v129, s[36:39], s57 offen sc1
    buffer_store_dwordx4 v[48:51], v129, s[36:39], s57 offen offset:256 sc1
    s_mov_b64 exec, -1
    s_waitcnt vmcnt(0)
    s_cmp_ge_u32 s63, 4
    s_cbranch_scc1 L_gt_ok
L_gt:
    ds_read_b32 v15, v14
    s_waitcnt lgkmcnt(0)
    v_readfirstlane_b32 s63, v15
    s_nop 0
    s_cmp_ge_u32 s63, 4
    s_cbranch_scc1 L_gt_ok
    s_sleep 1
    s_branch L_gt
L_gt_ok:
    s_mov_b32 s35, 0
    buffer_load_dwordx4 v[32:35], v4, s[36:39], s56 offen sc1
    buffer_load_dwordx4 v[36:39], v4, s[36:39], s56 offen offset:1024 sc1
    buffer_load_dwordx4 v[40:43], v4, s[36:39], s56 offen offset:2048 sc1
    buffer_load_dwordx4 v[44:47], v4, s[36:39], s56 offen offset:3072 sc1
    s_waitcnt vmcnt(0)
    v_bitop3_b32 v56, v32, v33, v9 bitop3:0x7e
    v_bitop3_b32 v57, v34, v35, v9 bitop3:0x7e
    v_bitop3_b32 v58, v36, v37, v9 bitop3:0x7e
    v_or3_b32 v56, v56, v57, v58
    v_bitop3_b32 v57, v38, v39, v9 bitop3:0x7e
    v_bitop3_b32 v58, v40, v41, v9 bitop3:0x7e
    v_or3_b32 v56, v56, v57, v58
    v_bitop3_b32 v57, v42, v43, v9 bitop3:0x7e
    v_bitop3_b32 v58, v44, v45, v9 bitop3:0x7e
    v_or3_b32 v56, v56, v57, v58
    v_bitop3_b32 v57, v46, v47, v9 bitop3:0x7e
    v_or_b32 v56, v56, v57
    v_and_b32 v56, 1023, v56
    v_cmp_ne_u32 vcc, 0, v56
    s_cbranch_vccnz L_gug_retry
L_gug_done:
    v_and_b32 v32, s47, v32
    v_and_b32 v33, s47, v33
    v_and_b32 v34, s47, v34
    v_and_b32 v35, s47, v35
    v_and_b32 v36, s47, v36
    v_and_b32 v37, s47, v37
    v_and_b32 v38, s47, v38
    v_and_b32 v39, s47, v39
    v_and_b32 v40, s47, v40
    v_and_b32 v41, s47, v41
    v_and_b32 v42, s47, v42
    v_and_b32 v43, s47, v43
    v_and_b32 v44, s47, v44
    v_and_b32 v45, s47, v45
    v_and_b32 v46, s47, v46
    v_and_b32 v47, s47, v47
    v_pk_add_f32 v[32:33], v[32:33], v[36:37]
    v_pk_add_f32 v[34:35], v[34:35], v[38:39]
    v_pk_add_f32 v[40:41], v[40:41], v[44:45]
    v_pk_add_f32 v[42:43], v[42:43], v[46:47]
    v_pk_add_f32 v[32:33], v[32:33], v[40:41]
    v_pk_add_f32 v[34:35], v[34:35], v[42:43]
    s_nop 1
    v_permlane32_swap_b32 v32, v34
    v_permlane32_swap_b32 v33, v35
    v_pk_add_f32 v[34:35], v[32:33], v[34:35]
    v_cvt_pk_bf16_f32 v35, v34, v35
    v_lshlrev_b32 v34, 16, v35
    v_and_b32 v35, 0xffff0000, v35
    v_mov_b32 v32, v34
    v_mov_b32 v33, v35
    s_nop 0
    v_permlane16_swap_b32 v32, v34
    v_permlane16_swap_b32 v33, v35
    s_mov_b32 s60, 3184710632
    v_mov_b32 v18, 3222493025
    v_mul_f32 v48, v32, v32
    v_mul_f32 v49, v33, v33
    v_fma_f32 v48, v48, s60, v18
    v_fma_f32 v49, v49, s60, v18
    v_mul_f32 v48, v48, v32
    v_mul_f32 v49, v49, v33
    v_exp_f32 v48, v48
    v_exp_f32 v49, v49
    v_add_f32 v48, 1.0, v48
    v_add_f32 v49, 1.0, v49
    v_rcp_f32 v48, v48
    v_rcp_f32 v49, v49
    v_mul_f32 v32, v32, v48
    v_mul_f32 v33, v33, v49
    v_cvt_pk_bf16_f32 v33, v32, v33
    v_lshlrev_b32 v32, 16, v33
    v_and_b32 v33, 0xffff0000, v33
    v_pk_mul_f32 v[32:33], v[32:33], v[34:35]
    v_cvt_pk_bf16_f32 v32, v32, v33
    ds_write_b32 v131, v32
    ds_read2_b64 v[24:27], v133 offset0:0 offset1:4
    ds_read2_b64 v[28:31], v133 offset0:8 offset1:12
    s_cmp_ge_u32 s63, 5
    s_cbranch_scc1 L_dn_ok
L_dn:
    ds_read_b32 v15, v14
    s_waitcnt lgkmcnt(0)
    v_readfirstlane_b32 s63, v15
    s_nop 0
    s_cmp_ge_u32 s63, 5
    s_cbranch_scc1 L_dn_ok
    s_sleep 1
    s_branch L_dn
L_dn_ok:
    ds_read_b64_tr_b16 v[64:65], v10 offset:49152
    ds_read_b64_tr_b16 v[66:67], v10 offset:51200
    ds_read_b64_tr_b16 v[68:69], v11 offset:49152
    ds_read_b64_tr_b16 v[70:71], v11 offset:51200
    ds_read_b64_tr_b16 v[72:73], v12 offset:49152
    ds_read_b64_tr_b16 v[74:75], v12 offset:51200
    ds_read_b64_tr_b16 v[76:77], v13 offset:49152
    ds_read_b64_tr_b16 v[78:79], v13 offset:51200
    ds_read_b64_tr_b16 v[80:81], v10 offset:53248
    ds_read_b64_tr_b16 v[82:83], v10 offset:55296
    ds_read_b64_tr_b16 v[84:85], v11 offset:53248
    ds_read_b64_tr_b16 v[86:87], v11 offset:55296
    ds_read_b64_tr_b16 v[88:89], v12 offset:53248
    ds_read_b64_tr_b16 v[90:91], v12 offset:55296
    ds_read_b64_tr_b16 v[92:93], v13 offset:53248
    ds_read_b64_tr_b16 v[94:95], v13 offset:55296
    s_waitcnt lgkmcnt(14)
    v_mfma_f32_16x16x32_bf16 v[32:35], v[64:67], v[24:27], 0
    s_waitcnt lgkmcnt(12)
    v_mfma_f32_16x16x32_bf16 v[36:39], v[68:71], v[24:27], 0
    s_waitcnt lgkmcnt(10)
    v_mfma_f32_16x16x32_bf16 v[40:43], v[72:75], v[24:27], 0
    s_waitcnt lgkmcnt(8)
    v_mfma_f32_16x16x32_bf16 v[44:47], v[76:79], v[24:27], 0
    s_waitcnt lgkmcnt(6)
    v_mfma_f32_16x16x32_bf16 v[32:35], v[80:83], v[28:31], v[32:35]
    s_waitcnt lgkmcnt(4)
    v_mfma_f32_16x16x32_bf16 v[36:39], v[84:87], v[28:31], v[36:39]
    s_waitcnt lgkmcnt(2)
    v_mfma_f32_16x16x32_bf16 v[40:43], v[88:91], v[28:31], v[40:43]
    s_waitcnt lgkmcnt(0)
    v_mfma_f32_16x16x32_bf16 v[44:47], v[92:95], v[28:31], v[44:47]
    s_nop 3
    v_cndmask_b32 v32, v32, v36, s[48:49]
    v_cndmask_b32 v33, v33, v37, s[48:49]
    v_cndmask_b32 v34, v34, v38, s[48:49]
    v_cndmask_b32 v35, v35, v39, s[48:49]
    v_cndmask_b32 v32, v32, v40, s[50:51]
    v_cndmask_b32 v33, v33, v41, s[50:51]
    v_cndmask_b32 v34, v34, v42, s[50:51]
    v_cndmask_b32 v35, v35, v43, s[50:51]
    v_cndmask_b32 v32, v32, v44, s[52:53]
    v_cndmask_b32 v33, v33, v45, s[52:53]
    v_cndmask_b32 v34, v34, v46, s[52:53]
    v_cndmask_b32 v35, v35, v47, s[52:53]
    v_and_or_b32 v32, v32, s47, v9
    v_and_or_b32 v33, v33, s47, v9
    v_and_or_b32 v34, v34, s47, v9
    v_and_or_b32 v35, v35, s47, v9
    s_mov_b64 exec, s[54:55]
    buffer_store_dwordx4 v[32:35], v132, s[36:39], s58 offen sc1
    s_mov_b64 exec, -1
    s_barrier
    s_endpgm
L_final:
    s_add_u32 s34, s33, 0
    s_and_b32 s34, s34, 31
    s_lshl_b32 s56, s34, 11
    s_add_u32 s58, s56, 393216
    s_lshl_b32 s56, s56, 0
    s_add_u32 s56, s56, 327680
    v_lshrrev_b32 v130, 2, v1
    v_lshlrev_b32 v130, 7, v130
    v_and_b32 v131, 3, v1
    v_lshl_add_u32 v130, v131, 4, v130
    s_lshl_b32 s60, s34, 5
    s_mov_b32 s61, s34
    v_and_b32 v129, 3, v1
    v_lshlrev_b32 v129, 3, v129
    v_lshl_add_u32 v129, v3, 1, v129
    s_waitcnt vmcnt(0)
    buffer_load_ushort v20, v129, s[40:43], s60 offen
    s_mov_b32 s46, 1069066811
    s_waitcnt lgkmcnt(0)
    s_add_u32 s44, s44, 1
    s_and_b32 s45, s44, 1023
    v_mov_b32 v9, s45
    v_mov_b32 v44, v9
    v_mov_b32 v45, v9
    v_mov_b32 v46, v9
    v_mov_b32 v47, v9
    s_mov_b32 s18, -1
    s_mov_b32 s19, 0xffff
    s_waitcnt vmcnt(0)
    v_lshlrev_b32 v20, 16, v20
    s_mov_b32 s40, s22
    s_mov_b32 s41, s23
    s_mov_b32 s42, 1024
    s_mov_b32 s43, 0x20000
    s_barrier
    s_mov_b32 s35, 0
    buffer_load_dwordx4 v[40:43], v4, s[36:39], s58 offen sc1
    s_mov_b64 exec, s[18:19]
    buffer_load_dwordx4 v[44:47], v4, s[36:39], s58 offen offset:1024 sc1
    s_mov_b64 exec, -1
    buffer_load_dwordx4 v[24:27], v4, s[36:39], s56 offen sc1
    buffer_load_dwordx4 v[28:31], v4, s[36:39], s56 offen offset:1024 sc1
    s_waitcnt vmcnt(2)
    v_bitop3_b32 v56, v40, v41, v9 bitop3:0x7e
    v_bitop3_b32 v57, v42, v43, v9 bitop3:0x7e
    v_bitop3_b32 v58, v44, v45, v9 bitop3:0x7e
    v_or3_b32 v56, v56, v57, v58
    v_bitop3_b32 v57, v46, v47, v9 bitop3:0x7e
    v_or_b32 v56, v56, v57
    v_and_b32 v56, 1023, v56
    v_cmp_ne_u32 vcc, 0, v56
    s_cbranch_vccnz L_gg_retry
L_gg_done:
    v_and_b32 v40, s47, v40
    v_and_b32 v41, s47, v41
    v_and_b32 v42, s47, v42
    v_and_b32 v43, s47, v43
    v_and_b32 v44, s47, v44
    v_and_b32 v45, s47, v45
    v_and_b32 v46, s47, v46
    v_and_b32 v47, s47, v47
    v_pk_add_f32 v[40:41], v[40:41], v[44:45]
    v_pk_add_f32 v[42:43], v[42:43], v[46:47]
    s_nop 1
    v_permlane32_swap_b32 v40, v42
    v_permlane32_swap_b32 v41, v43
    v_pk_add_f32 v[40:41], v[40:41], v[42:43]
    s_nop 1
    v_permlane16_swap_b32 v40, v41
    v_add_f32 v40, v40, v41
    s_nop 1
    v_add_f32_dpp v40, v40, v40 row_ror:8 row_mask:0xf bank_mask:0xf
    s_nop 1
    v_add_f32_dpp v40, v40, v40 row_ror:4 row_mask:0xf bank_mask:0xf
    v_cvt_pk_bf16_f32 v40, v40, v40
    v_lshlrev_b32 v40, 16, v40
    v_mul_f32 v44, s46, v40
    v_exp_f32 v44, -v44
    s_nop 0
    v_add_f32 v44, 1.0, v44
    v_rcp_f32 v44, v44
    s_nop 0
    v_mul_f32 v40, v40, v44
    v_cvt_pk_bf16_f32 v40, v40, v40
    v_lshlrev_b32 v40, 16, v40
    buffer_load_dwordx4 v[32:35], v4, s[36:39], s56 offen sc1
    buffer_load_dwordx4 v[36:39], v4, s[36:39], s56 offen offset:1024 sc1
L_za:
    s_waitcnt vmcnt(2)
    v_bitop3_b32 v56, v24, v25, v9 bitop3:0x7e
    v_bitop3_b32 v57, v26, v27, v9 bitop3:0x7e
    v_bitop3_b32 v58, v28, v29, v9 bitop3:0x7e
    v_or3_b32 v56, v56, v57, v58
    v_bitop3_b32 v57, v30, v31, v9 bitop3:0x7e
    v_or_b32 v56, v56, v57
    v_and_b32 v56, 1023, v56
    v_cmp_ne_u32 vcc, 0, v56
    s_cbranch_vccnz L_zb
L_sg_done:
    v_and_b32 v64, s47, v24
    v_and_b32 v65, s47, v25
    v_and_b32 v66, s47, v26
    v_and_b32 v67, s47, v27
    v_and_b32 v68, s47, v28
    v_and_b32 v69, s47, v29
    v_and_b32 v70, s47, v30
    v_and_b32 v71, s47, v31
L_zd:
    v_pk_add_f32 v[64:65], v[64:65], v[68:69]
    v_pk_add_f32 v[66:67], v[66:67], v[70:71]
    s_nop 1
    v_permlane32_swap_b32 v64, v66
    v_permlane32_swap_b32 v65, v67
    v_pk_add_f32 v[64:65], v[64:65], v[66:67]
    s_nop 1
    v_permlane16_swap_b32 v64, v65
    v_add_f32 v64, v64, v65
    s_nop 1
    v_add_f32_dpp v64, v64, v64 row_ror:8 row_mask:0xf bank_mask:0xf
    s_nop 1
    v_add_f32_dpp v64, v64, v64 row_ror:4 row_mask:0xf bank_mask:0xf
    v_cvt_pk_bf16_f32 v64, v64, v64
    v_lshlrev_b32 v64, 16, v64
    v_mul_f32 v64, v64, v40
    v_cvt_pk_bf16_f32 v64, v64, v64
    v_lshlrev_b32 v64, 16, v64
    v_add_f32 v64, v64, v20
    v_cvt_pk_bf16_f32 v64, v64, v64
    s_mov_b64 exec, s[54:55]
    buffer_store_short v64, v129, s[40:43], s60 offen
    s_cmp_lg_u32 s61, 31
    s_cbranch_scc1 L_fin
    s_mov_b64 exec, 1
    v_mov_b32 v16, s44
    buffer_store_dword v16, off, s[36:39], 0
L_fin:
L_stop:
    s_endpgm
L_gug_retry:
    s_sleep 2
    s_mov_b64 exec, vcc
    buffer_load_dwordx4 v[32:35], v4, s[36:39], s56 offen sc1
    buffer_load_dwordx4 v[36:39], v4, s[36:39], s56 offen offset:1024 sc1
    buffer_load_dwordx4 v[40:43], v4, s[36:39], s56 offen offset:2048 sc1
    buffer_load_dwordx4 v[44:47], v4, s[36:39], s56 offen offset:3072 sc1
    s_mov_b64 exec, -1
    s_add_u32 s35, s35, 1
    s_cmp_ge_u32 s35, 300000
    s_waitcnt vmcnt(0)
    s_cbranch_scc1 L_gug_done
    v_bitop3_b32 v56, v32, v33, v9 bitop3:0x7e
    v_bitop3_b32 v57, v34, v35, v9 bitop3:0x7e
    v_bitop3_b32 v58, v36, v37, v9 bitop3:0x7e
    v_or3_b32 v56, v56, v57, v58
    v_bitop3_b32 v57, v38, v39, v9 bitop3:0x7e
    v_bitop3_b32 v58, v40, v41, v9 bitop3:0x7e
    v_or3_b32 v56, v56, v57, v58
    v_bitop3_b32 v57, v42, v43, v9 bitop3:0x7e
    v_bitop3_b32 v58, v44, v45, v9 bitop3:0x7e
    v_or3_b32 v56, v56, v57, v58
    v_bitop3_b32 v57, v46, v47, v9 bitop3:0x7e
    v_or_b32 v56, v56, v57
    v_and_b32 v56, 1023, v56
    v_cmp_ne_u32 vcc, 0, v56
    s_cbranch_vccnz L_gug_retry
    s_branch L_gug_done
L_gg_retry:
    s_add_u32 s35, s35, 1
    s_cmp_ge_u32 s35, 300000
    s_cbranch_scc1 L_gg_done
    s_mov_b64 exec, vcc
    buffer_load_dwordx4 v[40:43], v4, s[36:39], s58 offen sc1
    s_and_b64 exec, exec, s[18:19]
    buffer_load_dwordx4 v[44:47], v4, s[36:39], s58 offen offset:1024 sc1
    s_mov_b64 exec, -1
    buffer_load_dwordx4 v[24:27], v4, s[36:39], s56 offen sc1
    buffer_load_dwordx4 v[28:31], v4, s[36:39], s56 offen offset:1024 sc1
    s_waitcnt vmcnt(0)
    v_bitop3_b32 v56, v40, v41, v9 bitop3:0x7e
    v_bitop3_b32 v57, v42, v43, v9 bitop3:0x7e
    v_bitop3_b32 v58, v44, v45, v9 bitop3:0x7e
    v_or3_b32 v56, v56, v57, v58
    v_bitop3_b32 v57, v46, v47, v9 bitop3:0x7e
    v_or_b32 v56, v56, v57
    v_and_b32 v56, 1023, v56
    v_cmp_ne_u32 vcc, 0, v56
    s_cbranch_vccnz L_gg_retry
    s_branch L_gg_done
L_zb:
    buffer_load_dwordx4 v[24:27], v4, s[36:39], s56 offen sc1
    buffer_load_dwordx4 v[28:31], v4, s[36:39], s56 offen offset:1024 sc1
    s_add_u32 s35, s35, 1
    s_cmp_ge_u32 s35, 300000
    s_waitcnt vmcnt(2)
    s_cbranch_scc1 L_zc
    v_bitop3_b32 v56, v32, v33, v9 bitop3:0x7e
    v_bitop3_b32 v57, v34, v35, v9 bitop3:0x7e
    v_bitop3_b32 v58, v36, v37, v9 bitop3:0x7e
    v_or3_b32 v56, v56, v57, v58
    v_bitop3_b32 v57, v38, v39, v9 bitop3:0x7e
    v_or_b32 v56, v56, v57
    v_and_b32 v56, 1023, v56
    v_cmp_ne_u32 vcc, 0, v56
    s_cbranch_vccz L_zc
    buffer_load_dwordx4 v[32:35], v4, s[36:39], s56 offen sc1
    buffer_load_dwordx4 v[36:39], v4, s[36:39], s56 offen offset:1024 sc1
    s_branch L_za
L_zc:
    v_and_b32 v64, s47, v32
    v_and_b32 v65, s47, v33
    v_and_b32 v66, s47, v34
    v_and_b32 v67, s47, v35
    v_and_b32 v68, s47, v36
    v_and_b32 v69, s47, v37
    v_and_b32 v70, s47, v38
    v_and_b32 v71, s47, v39
    s_branch L_zd
L_end:
    s_endpgm
.section .rodata,"a"
.p2align 6
.amdhsa_kernel recurrent_scan__sliding_block_cached__geglu_ffn__decode_kernel
.amdhsa_next_free_vgpr 164
.amdhsa_next_free_sgpr 102
.amdhsa_accum_offset 164
.amdhsa_group_segment_fixed_size 0
.amdhsa_kernarg_size 96
.amdhsa_user_sgpr_count 2
.amdhsa_user_sgpr_kernarg_segment_ptr 1
.amdhsa_system_sgpr_workgroup_id_x 1
.end_amdhsa_kernel
```
